```python
import torch

def _softmax(x, axis=-1):
    return torch.softmax(x, dim=axis)
def _gelu(x):
    return torch.nn.functional.gelu(x, approximate="tanh")
def _silu(x):
    return torch.nn.functional.silu(x)
def _sigmoid(x):
    return torch.sigmoid(x)
def _layernorm(x, axis=-1, eps=1e-5):
    m = x.mean(dim=axis, keepdim=True)
    v = x.var(dim=axis, keepdim=True, unbiased=False)
    return (x - m) / torch.sqrt(v + eps)
def _scatter_add(tgt, idx, src, axis=0):
    return tgt.clone().index_add_(axis, idx, src)
def _segment_sum(src, seg, n):
    out = torch.zeros((n,) + src.shape[1:], dtype=src.dtype)
    return out.index_add_(0, seg, src)
def _pad(x, pw):
    flat = tuple(v for pair in reversed(pw) for v in pair)
    return torch.nn.functional.pad(x, flat)

kernel_name = 'concat_heads__sliding_block_cached__mha_block_cached__decode'

def setup_inputs():

    _w = (lambda a: (lambda t: t.to(torch.bfloat16) if t.is_floating_point() else t)(torch.as_tensor(a)))
    def _A_setup():
        B, Sq, D = 2, 1, 512
        Hq, Hkv, Sk, Dh = 32, 8, 8192, 128
        assert Hq % Hkv == 0, (Hq, Hkv)
        return {
            "x": _w((lambda *s: torch.randn(*s, dtype=torch.bfloat16) * 0.8)(B, Sq, D)),
            "k_cache": _w((lambda *s: torch.randn(*s, dtype=torch.bfloat16) * 1.6)(B, Hkv, Sk, Dh)),
            "v_cache": _w((lambda *s: torch.randn(*s, dtype=torch.bfloat16) * 0.2)(B, Hkv, Sk, Dh)),
            "wq": _w((lambda *s: torch.randn(*s, dtype=torch.bfloat16) * 1.6)(D, Hq * Dh) * (D ** -0.5)),
            "wo": _w((lambda *s: torch.randn(*s, dtype=torch.bfloat16) * 0.2)(Hq * Dh, D) * ((Hq * Dh) ** -0.5)),
        }
    _A_in = _A_setup()

    def _B_setup():
        B, Sq, D = 2, 1, 512
        H, Sk, Dh = 32, 8192, 128
        return {
            "x": _w((lambda *s: torch.randn(*s, dtype=torch.bfloat16) * 0.8)(B, Sq, D)),
            "k_cache": _w((lambda *s: torch.randn(*s, dtype=torch.bfloat16) * 1.6)(B, H, Sk, Dh)),
            "v_cache": _w((lambda *s: torch.randn(*s, dtype=torch.bfloat16) * 0.2)(B, H, Sk, Dh)),
            "wq": _w((lambda *s: torch.randn(*s, dtype=torch.bfloat16) * 1.6)(D, H * Dh) * (D ** -0.5)),
            "wo": _w((lambda *s: torch.randn(*s, dtype=torch.bfloat16) * 0.2)(H * Dh, D) * ((H * Dh) ** -0.5)),
        }
    _B_in = _B_setup()

    return {
        "A_x": _A_in["x"],
        "A_k_cache": _A_in["k_cache"],
        "A_v_cache": _A_in["v_cache"],
        "A_wq": _A_in["wq"],
        "A_wo": _A_in["wo"],
        "B_x": _B_in["x"],
        "B_k_cache": _B_in["k_cache"],
        "B_v_cache": _B_in["v_cache"],
        "B_wq": _B_in["wq"],
        "B_wo": _B_in["wo"],
    }

def reference(A_x, A_k_cache, A_v_cache, A_wq, A_wo, B_x, B_k_cache, B_v_cache, B_wq, B_wo):
    def _A_ref(x, k_cache, v_cache, wq, wo):
        B, Sq, D = x.shape
        Hq, Dh = 32, 128
        Hkv, Sk = k_cache.shape[1], k_cache.shape[2]
        W = min(4096, max(256, Sk // 4))
        rep = Hq // Hkv
        q = (lambda x, *d: x.permute(*d))((x @ wq).reshape(B, Sq, Hq, Dh), 0, 2, 1, 3)
        k = (lambda x, n, axis: torch.repeat_interleave(x, n, dim=axis))(k_cache[:, :, Sk - W:, :], rep, axis=1)
        v = (lambda x, n, axis: torch.repeat_interleave(x, n, dim=axis))(v_cache[:, :, Sk - W:, :], rep, axis=1)
        scores = torch.einsum("bhqd,bhkd->bhqk", q, k) * (Dh ** -0.5)
        p = _softmax(scores, axis=-1)
        o = torch.einsum("bhqk,bhkd->bhqd", p, v)
        return (lambda x, *d: x.permute(*d))(o, 0, 2, 1, 3).reshape(B, Sq, Hq * Dh) @ wo

    def _B_ref(x, k_cache, v_cache, wq, wo):
        B, Sq, D = x.shape
        H, Dh = 32, 128
        q = (lambda x, *d: x.permute(*d))((x @ wq).reshape(B, Sq, H, Dh), 0, 2, 1, 3)
        scores = torch.einsum("bhqd,bhkd->bhqk", q, k_cache) * (Dh ** -0.5)
        p = _softmax(scores, axis=-1)
        o = torch.einsum("bhqk,bhkd->bhqd", p, v_cache)
        return (lambda x, *d: x.permute(*d))(o, 0, 2, 1, 3).reshape(B, Sq, H * Dh) @ wo

    a = _A_ref(A_x, A_k_cache, A_v_cache, A_wq, A_wo)
    b = _B_ref(B_x, B_k_cache, B_v_cache, B_wq, B_wo)
    return torch.concatenate([a, b], axis=-1)
```

```asm
; @launch grid=(256,1,1) block=(512,1,1) lds=34816
.amdgcn_target "amdgcn-amd-amdhsa--gfx950"
.text
.globl concat_heads__sliding_block_cached__mha_block_cached__decode_kernel
.p2align 8
.type concat_heads__sliding_block_cached__mha_block_cached__decode_kernel,@function
concat_heads__sliding_block_cached__mha_block_cached__decode_kernel:
  s_cmp_ge_u32 s2, 256
  s_cbranch_scc1 L_end
  s_and_b32 s7, s2, 1
  s_mul_i32 s7, s7, 40
  s_add_u32 s50, s7, 24
  s_load_dwordx2 s[12:13], s[0:1], s50
  s_load_dwordx2 s[8:9], s[0:1], s7
  s_load_dwordx2 s[28:29], s[0:1], 48
  s_load_dwordx2 s[44:45], s[0:1], 96
  s_load_dwordx2 s[16:17], s[0:1], 8
  v_lshrrev_b32 v1, 6, v0
  v_and_b32 v0, 63, v0
  v_readfirstlane_b32 s3, v1
  s_mov_b32 s14, 0x400000
  s_mov_b32 s15, 0x20000
  s_mov_b32 s10, 0x800
  s_mov_b32 s11, 0x20000
  v_lshrrev_b32 v5, 4, v0
  v_and_b32 v6, 15, v0
  v_lshlrev_b32 v7, 4, v6
  v_lshl_add_u32 v9, v5, 15, v7
  v_bfe_u32 v8, v0, 3, 1
  v_lshlrev_b32 v8, 10, v8
  v_lshl_add_u32 v8, v5, 3, v8
  s_lshr_b32 s49, s2, 3
  s_and_b32 s7, s2, 6
  s_lshl_b32 s7, s7, 2
  s_add_u32 s7, s7, s3
  s_lshl_b32 s61, s7, 5
  s_lshl_b32 s53, s7, 17
  s_lshl_b32 s50, s49, 8
  s_add_u32 s53, s53, s50
  s_waitcnt lgkmcnt(0)
  buffer_load_dwordx2 v[10:11], v8, s[8:11], s61 offen
  buffer_load_dwordx4 v[92:95], v9, s[12:15], s53 offen nt
  s_add_u32 s55, s53, 8192
  buffer_load_dwordx4 v[96:99], v9, s[12:15], s55 offen nt
  s_add_u32 s55, s53, 16384
  buffer_load_dwordx4 v[100:103], v9, s[12:15], s55 offen nt
  s_add_u32 s55, s53, 24576
  buffer_load_dwordx4 v[104:107], v9, s[12:15], s55 offen nt
  s_mov_b32 s30, 0x8000000
  s_mov_b32 s31, 0x20000
  v_lshlrev_b32 v1, 4, v0
  s_and_b32 s48, s2, 7
  s_lshr_b32 s4, s49, 3
  s_lshl_b32 s7, s48, 2
  s_add_u32 s4, s4, s7
  s_bfe_u32 s5, s49, 0x10002
  s_and_b32 s6, s49, 3
  s_lshl_b32 s56, s5, 5
  s_add_u32 s56, s56, s4
  s_lshl_b32 s56, s56, 2
  s_add_u32 s56, s56, s6
  s_bfe_u32 s7, s3, 0x10002
  s_lshl_b32 s52, s7, 16
  s_bfe_u32 s7, s3, 0x10000
  s_lshl_b32 s7, s7, 12
  s_or_b32 s52, s52, s7
  s_bfe_u32 s7, s3, 0x10001
  s_lshl_b32 s7, s7, 13
  s_or_b32 s52, s52, s7
  s_bfe_u32 s7, s2, 0x10001
  s_lshl_b32 s7, s7, 14
  s_or_b32 s52, s52, s7
  s_bfe_u32 s7, s2, 0x10002
  s_lshl_b32 s7, s7, 11
  s_or_b32 s52, s52, s7
  s_bfe_u32 s7, s2, 0x10004
  s_lshl_b32 s7, s7, 15
  s_or_b32 s52, s52, s7
  s_bfe_u32 s7, s2, 0x10003
  s_lshl_b32 s7, s7, 10
  s_or_b32 s52, s52, s7
  s_lshl_b32 s51, s56, 19
  s_or_b32 s51, s51, s52
  s_bfe_u32 s7, s2, 0x10006
  s_lshl_b32 s7, s7, 17
  s_or_b32 s51, s51, s7
  s_bfe_u32 s7, s2, 0x10007
  s_lshl_b32 s7, s7, 18
  s_or_b32 s51, s51, s7
  buffer_load_dwordx4 v[108:111], v1, s[28:31], s51 offen nt
  s_lshl_b32 s7, s5, 3
  s_add_u32 s7, s7, s48
  s_lshl_b32 s7, s7, 4
  s_add_u32 s7, s7, s6
  s_add_u32 s7, s7, 12
  s_lshl_b32 s7, s7, 17
  s_or_b32 s52, s52, s7
  s_mov_b32 s18, 0x2000000
  s_mov_b32 s19, 0x20000
  s_mov_b32 s22, 0x2000000
  s_mov_b32 s23, 0x20000
  s_mov_b32 s26, 0x400000
  s_mov_b32 s27, 0x20000
  s_mov_b32 s34, 0x8000000
  s_mov_b32 s35, 0x20000
  s_mov_b32 s38, 0x400000
  s_mov_b32 s39, 0x20000
  s_mov_b32 s42, 0x1000
  s_mov_b32 s43, 0x20000
  s_mov_b32 s46, 0x400000
  s_mov_b32 s47, 0x20000
  s_mov_b32 s60, 0x1b0000
  buffer_load_dword v15, off, s[44:47], s60 sc1
  s_load_dwordx2 s[20:21], s[0:1], 16
  s_load_dwordx2 s[32:33], s[0:1], 56
  s_load_dwordx2 s[24:25], s[0:1], 32
  s_load_dwordx2 s[36:37], s[0:1], 72
  s_load_dwordx2 s[40:41], s[0:1], 80
  v_and_b32 v7, 1, v0
  v_lshlrev_b32 v7, 4, v7
  v_mov_b32 v8, 0xffff
  v_lshlrev_b32 v7, v7, v8
  v_bfe_u32 v8, v0, 1, 2
  v_cmp_eq_u32 vcc, 0, v8
  s_nop 1
  v_cndmask_b32 v32, 0, v7, vcc
  v_cmp_eq_u32 vcc, 1, v8
  s_nop 1
  v_cndmask_b32 v33, 0, v7, vcc
  v_cmp_eq_u32 vcc, 2, v8
  s_nop 1
  v_cndmask_b32 v34, 0, v7, vcc
  v_cmp_eq_u32 vcc, 3, v8
  s_nop 1
  v_cndmask_b32 v35, 0, v7, vcc
  v_and_b32 v7, 1, v5
  v_lshlrev_b32 v7, 4, v7
  v_lshl_add_u32 v7, v6, 5, v7
  v_lshrrev_b32 v8, 1, v5
  v_lshl_add_u32 v7, v8, 12, v7
  s_lshl_b32 s7, s3, 9
  v_add_u32 v3, s7, v7
  s_mov_b32 s50, 0
  s_bfe_u32 s7, s4, 0x10002
  s_lshl_b32 s7, s7, 0
  s_or_b32 s50, s50, s7
  s_bfe_u32 s7, s4, 0x10000
  s_lshl_b32 s7, s7, 1
  s_or_b32 s50, s50, s7
  s_bfe_u32 s7, s4, 0x10001
  s_lshl_b32 s7, s7, 2
  s_or_b32 s50, s50, s7
  s_bfe_u32 s7, s4, 0x10003
  s_lshl_b32 s7, s7, 3
  s_or_b32 s50, s50, s7
  v_lshrrev_b32 v7, 2, v0
  v_xor_b32 v7, s50, v7
  v_lshlrev_b32 v7, 2, v7
  v_and_b32 v8, 3, v0
  v_mul_u32_u24 v8, 1056, v8
  v_add_u32 v7, v7, v8
  s_lshl_b32 s7, s3, 6
  s_add_u32 s7, s7, 12288
  v_add_u32 v4, s7, v7
  s_lshl_b32 s54, s4, 17
  s_lshl_b32 s7, s3, 14
  s_or_b32 s54, s54, s7
  s_lshl_b32 s50, s50, 10
  s_or_b32 s54, s54, s50
  v_or_b32 v88, v32, v34
  v_or_b32 v89, v33, v35
  s_lshl_b32 s7, s3, 11
  v_add_u32 v85, s7, v1
  s_lshl_b32 s7, s3, 8
  v_lshlrev_b32 v7, 2, v0
  v_add_u32 v82, s7, v7
  s_movk_i32 s74, 0xfff
  s_mov_b32 s62, 0xcccccccc
  s_mov_b32 s63, 0xcccccccc
  s_mov_b32 s64, 0xaaaaaaaa
  s_mov_b32 s65, 0xaaaaaaaa
  s_mov_b32 s58, 0x3db504f3
  s_mov_b32 s59, 0x3fb8aa3b
  s_mov_b32 s7, 0x01000100
  s_mov_b32 s50, 0x03020302
  s_waitcnt vmcnt(6)
  v_perm_b32 v60, v10, v10, s7
  v_perm_b32 v61, v10, v10, s50
  v_perm_b32 v62, v11, v11, s7
  v_perm_b32 v63, v11, v11, s50
  v_and_b32 v36, v60, v32
  v_and_b32 v37, v60, v33
  v_and_b32 v38, v60, v34
  v_and_b32 v39, v60, v35
  s_waitcnt vmcnt(5)
  s_nop 0
  v_mfma_f32_16x16x32_bf16 v[28:31], v[36:39], v[92:95], 0
  v_and_b32 v40, v61, v32
  v_and_b32 v41, v61, v33
  v_and_b32 v42, v61, v34
  v_and_b32 v43, v61, v35
  s_waitcnt vmcnt(4)
  s_nop 0
  v_mfma_f32_16x16x32_bf16 v[28:31], v[40:43], v[96:99], v[28:31]
  v_and_b32 v36, v62, v32
  v_and_b32 v37, v62, v33
  v_and_b32 v38, v62, v34
  v_and_b32 v39, v62, v35
  s_waitcnt vmcnt(3)
  s_nop 0
  v_mfma_f32_16x16x32_bf16 v[28:31], v[36:39], v[100:103], v[28:31]
  v_and_b32 v40, v63, v32
  v_and_b32 v41, v63, v33
  v_and_b32 v42, v63, v34
  v_and_b32 v43, v63, v35
  s_waitcnt vmcnt(2)
  s_nop 0
  v_mfma_f32_16x16x32_bf16 v[28:31], v[40:43], v[104:107], v[28:31]
  buffer_load_dwordx4 v[112:115], v1, s[16:19], s52 offen
  v_cmp_gt_u32 vcc, 8, v6
  s_nop 1
  v_cndmask_b32 v32, 0, v32, vcc
  v_cndmask_b32 v33, 0, v33, vcc
  v_cndmask_b32 v34, 0, v34, vcc
  v_cndmask_b32 v35, 0, v35, vcc
  ds_write_b128 v3, v[28:31] offset:0
  s_lshl_b32 s7, s3, 4
  v_add_u32 v3, s7, v3
  s_bfe_u32 s7, s3, 0x10001
  s_lshl_b32 s7, s7, 12
  s_and_b32 s50, s3, 1
  s_lshl_b32 s50, s50, 8
  s_add_u32 s7, s7, s50
  v_lshlrev_b32 v7, 2, v0
  v_add_u32 v7, s7, v7
  s_xor_b32 s55, s51, 16384
  buffer_load_dwordx4 v[116:119], v1, s[28:31], s55 offen nt
  s_xor_b32 s55, s51, 2048
  buffer_load_dwordx4 v[120:123], v1, s[28:31], s55 offen nt
  s_xor_b32 s55, s52, 16384
  s_waitcnt vmcnt(4)
  buffer_load_dwordx4 v[124:127], v1, s[16:19], s55 offen
  s_xor_b32 s55, s51, 18432
  s_waitcnt vmcnt(4)
  buffer_load_dwordx4 v[128:131], v1, s[28:31], s55 offen nt
  s_barrier
  s_xor_b32 s55, s51, 32768
  s_waitcnt vmcnt(4)
  buffer_load_dwordx4 v[132:135], v1, s[28:31], s55 offen nt
  s_xor_b32 s55, s52, 2048
  s_waitcnt vmcnt(4)
  buffer_load_dwordx4 v[136:139], v1, s[16:19], s55 offen
  s_waitcnt lgkmcnt(0)
  s_barrier
  ds_read2st64_b32 v[44:45], v7 offset0:0 offset1:2
  ds_read2st64_b32 v[46:47], v7 offset0:4 offset1:6
  ds_read2st64_b32 v[48:49], v7 offset0:8 offset1:10
  ds_read2st64_b32 v[50:51], v7 offset0:12 offset1:14
  s_xor_b32 s55, s51, 49152
  s_waitcnt vmcnt(4)
  buffer_load_dwordx4 v[140:143], v1, s[28:31], s55 offen nt
  s_xor_b32 s55, s51, 34816
  s_waitcnt vmcnt(4)
  buffer_load_dwordx4 v[144:147], v1, s[28:31], s55 offen nt
  s_mov_b32 s57, 0x9e3779b1
  v_mul_lo_u32 v15, v15, s57
  v_add_u32 v15, 0x7f4a7c15, v15
  s_bfe_u32 s7, s3, 0x10001
  s_lshl_b32 s7, s7, 5
  s_add_u32 s7, s7, s49
  s_lshl_b32 s7, s7, 1
  s_and_b32 s55, s48, 1
  s_add_u32 s7, s7, s55
  s_lshl_b32 s7, s7, 2
  s_lshr_b32 s55, s48, 1
  s_add_u32 s7, s7, s55
  s_lshl_b32 s7, s7, 10
  s_lshl_b32 s50, s50, 1
  s_add_u32 s7, s7, s50
  s_add_u32 s7, s7, 1179648
  s_cmp_lt_u32 s3, 4
  s_cselect_b32 s7, s7, 1073741824
  v_lshlrev_b32 v7, 3, v0
  s_waitcnt lgkmcnt(0)
  v_add_f32 v44, v44, v48
  v_add_f32 v45, v45, v49
  v_add_f32 v46, v46, v50
  v_add_f32 v47, v47, v51
  v_add_f32 v44, v44, v46
  v_add_f32 v45, v45, v47
  v_add_f32 v44, v44, v45
  v_mov_b32 v45, v15
  buffer_store_dwordx2 v[44:45], v7, s[44:47], s7 offen sc1
  s_lshl_b32 s53, s5, 5
  s_add_u32 s53, s53, s4
  s_lshl_b32 s53, s53, 3
  s_add_u32 s53, s53, s3
  s_lshl_b32 s53, s53, 10
  s_add_u32 s53, s53, 1179648
  s_xor_b32 s55, s52, 18432
  s_waitcnt vmcnt(4)
  buffer_load_dwordx4 v[148:151], v1, s[16:19], s55 offen
  s_xor_b32 s55, s51, 51200
  s_waitcnt vmcnt(4)
  buffer_load_dwordx4 v[152:155], v1, s[28:31], s55 offen nt
  s_xor_b32 s55, s51, 1024
  s_waitcnt vmcnt(4)
  buffer_load_dwordx4 v[156:159], v1, s[28:31], s55 offen nt
  s_xor_b32 s55, s52, 32768
  s_waitcnt vmcnt(4)
  buffer_load_dwordx4 v[160:163], v1, s[16:19], s55 offen
  s_barrier
  s_xor_b32 s55, s51, 17408
  buffer_load_dwordx4 v[164:167], v1, s[28:31], s55 offen nt
  s_xor_b32 s55, s51, 3072
  buffer_load_dwordx4 v[168:171], v1, s[28:31], s55 offen nt
  s_xor_b32 s55, s52, 49152
  buffer_load_dwordx4 v[172:175], v1, s[16:19], s55 offen
  s_xor_b32 s55, s51, 19456
  buffer_load_dwordx4 v[176:179], v1, s[28:31], s55 offen nt
  s_xor_b32 s55, s51, 33792
  s_waitcnt vmcnt(4)
  buffer_load_dwordx4 v[180:183], v1, s[28:31], s55 offen nt
  s_xor_b32 s55, s52, 34816
  s_waitcnt vmcnt(4)
  buffer_load_dwordx4 v[184:187], v1, s[16:19], s55 offen
  s_barrier
  s_xor_b32 s55, s51, 50176
  s_waitcnt vmcnt(4)
  buffer_load_dwordx4 v[188:191], v1, s[28:31], s55 offen nt
  s_xor_b32 s55, s51, 35840
  s_waitcnt vmcnt(4)
  buffer_load_dwordx4 v[192:195], v1, s[28:31], s55 offen nt
  s_waitcnt vmcnt(4)
  buffer_load_dwordx4 v[196:199], v1, s[44:47], s53 offen sc1
  s_xor_b32 s55, s52, 51200
  s_waitcnt vmcnt(4)
  buffer_load_dwordx4 v[200:203], v1, s[16:19], s55 offen
  s_xor_b32 s55, s51, 52224
  s_waitcnt vmcnt(4)
  buffer_load_dwordx4 v[204:207], v1, s[28:31], s55 offen nt
  s_xor_b32 s55, s51, 131072
  s_waitcnt vmcnt(4)
  buffer_load_dwordx4 v[208:211], v1, s[28:31], s55 offen nt
  s_barrier
  s_xor_b32 s55, s52, 1024
  s_waitcnt vmcnt(4)
  buffer_load_dwordx4 v[212:215], v1, s[16:19], s55 offen
  s_xor_b32 s55, s51, 147456
  s_waitcnt vmcnt(4)
  buffer_load_dwordx4 v[216:219], v1, s[28:31], s55 offen nt
  s_mov_b32 s60, 0
L_qchk:
  v_cmp_ne_u32 vcc, v197, v15
  v_cmp_ne_u32 s[68:69], v199, v15
  s_nop 0
  s_or_b64 vcc, vcc, s[68:69]
  s_cbranch_scc0 L_qok
  buffer_load_dwordx4 v[196:199], v1, s[44:47], s53 offen sc1
  s_add_u32 s60, s60, 1
  s_cmp_lt_u32 s60, 0x20000
  s_waitcnt vmcnt(0)
  s_cbranch_scc1 L_qchk
L_qok:
  v_mov_b32 v197, v198
  v_lshlrev_b32 v7, 3, v0
  s_lshl_b32 s7, s3, 9
  v_add_u32 v7, s7, v7
  ds_write_b64 v7, v[196:197] offset:8192
  v_lshlrev_b32 v7, 5, v6
  v_lshl_add_u32 v7, v5, 3, v7
  s_waitcnt lgkmcnt(0)
  s_barrier
  ds_read_b64 v[44:45], v7 offset:10240
  ds_read_b64 v[46:47], v7 offset:10752
  ds_read_b64 v[48:49], v7 offset:11264
  ds_read_b64 v[50:51], v7 offset:11776
  ds_read_b64 v[60:61], v7 offset:8192
  ds_read_b64 v[62:63], v7 offset:8704
  ds_read_b64 v[64:65], v7 offset:9216
  ds_read_b64 v[66:67], v7 offset:9728
  s_xor_b32 s55, s51, 133120
  s_waitcnt vmcnt(4)
  buffer_load_dwordx4 v[220:223], v1, s[28:31], s55 offen nt
  s_waitcnt lgkmcnt(0)
  v_add_f32 v44, v44, v48
  v_add_f32 v45, v45, v49
  v_add_f32 v46, v46, v50
  v_add_f32 v47, v47, v51
  v_add_f32 v44, v44, v46
  v_add_f32 v45, v45, v47
  v_cvt_pk_bf16_f32 v16, v44, v45
  v_mov_b32 v17, v16
  s_nop 1
  v_permlane16_swap_b32 v16, v17
  v_mov_b32 v18, v16
  v_mov_b32 v19, v17
  s_nop 0
  v_permlane32_swap_b32 v16, v18
  v_permlane32_swap_b32 v17, v19
  v_add_f32 v60, v60, v64
  v_add_f32 v61, v61, v65
  v_add_f32 v62, v62, v66
  v_add_f32 v63, v63, v67
  v_add_f32 v60, v60, v62
  v_add_f32 v61, v61, v63
  v_cvt_pk_bf16_f32 v20, v60, v61
  v_mov_b32 v21, v20
  s_nop 1
  v_permlane16_swap_b32 v20, v21
  v_mov_b32 v22, v20
  v_mov_b32 v23, v21
  s_nop 0
  v_permlane32_swap_b32 v20, v22
  v_permlane32_swap_b32 v21, v23
  v_dot2_f32_bf16 v44, v108, v16, 0
  v_dot2_f32_bf16 v44, v109, v17, v44
  v_dot2_f32_bf16 v44, v110, v18, v44
  v_dot2_f32_bf16 v44, v111, v19, v44
  s_xor_b32 s55, s52, 17408
  s_waitcnt vmcnt(4)
  buffer_load_dwordx4 v[224:227], v1, s[16:19], s55 offen
  v_dot2_f32_bf16 v60, v112, v20, 0
  v_dot2_f32_bf16 v60, v113, v21, v60
  v_dot2_f32_bf16 v60, v114, v22, v60
  v_dot2_f32_bf16 v60, v115, v23, v60
  v_dot2_f32_bf16 v45, v116, v16, 0
  v_dot2_f32_bf16 v45, v117, v17, v45
  v_dot2_f32_bf16 v45, v118, v18, v45
  v_dot2_f32_bf16 v45, v119, v19, v45
  s_xor_b32 s55, s51, 149504
  s_waitcnt vmcnt(4)
  buffer_load_dwordx4 v[228:231], v1, s[28:31], s55 offen nt
  v_dot2_f32_bf16 v46, v120, v16, 0
  v_dot2_f32_bf16 v46, v121, v17, v46
  v_dot2_f32_bf16 v46, v122, v18, v46
  v_dot2_f32_bf16 v46, v123, v19, v46
  v_dot2_f32_bf16 v61, v124, v20, 0
  v_dot2_f32_bf16 v61, v125, v21, v61
  v_dot2_f32_bf16 v61, v126, v22, v61
  v_dot2_f32_bf16 v61, v127, v23, v61
  s_xor_b32 s55, s51, 163840
  s_waitcnt vmcnt(4)
  buffer_load_dwordx4 v[232:235], v1, s[28:31], s55 offen nt
  v_dot2_f32_bf16 v47, v128, v16, 0
  v_dot2_f32_bf16 v47, v129, v17, v47
  v_dot2_f32_bf16 v47, v130, v18, v47
  v_dot2_f32_bf16 v47, v131, v19, v47
  v_dot2_f32_bf16 v48, v132, v16, 0
  v_dot2_f32_bf16 v48, v133, v17, v48
  v_dot2_f32_bf16 v48, v134, v18, v48
  v_dot2_f32_bf16 v48, v135, v19, v48
  s_xor_b32 s55, s52, 3072
  s_waitcnt vmcnt(4)
  buffer_load_dwordx4 v[236:239], v1, s[16:19], s55 offen
  v_dot2_f32_bf16 v62, v136, v20, 0
  v_dot2_f32_bf16 v62, v137, v21, v62
  v_dot2_f32_bf16 v62, v138, v22, v62
  v_dot2_f32_bf16 v62, v139, v23, v62
  v_dot2_f32_bf16 v49, v140, v16, 0
  v_dot2_f32_bf16 v49, v141, v17, v49
  v_dot2_f32_bf16 v49, v142, v18, v49
  v_dot2_f32_bf16 v49, v143, v19, v49
  s_xor_b32 s55, s51, 180224
  s_waitcnt vmcnt(4)
  buffer_load_dwordx4 v[240:243], v1, s[28:31], s55 offen nt
  s_barrier
  v_dot2_f32_bf16 v50, v144, v16, 0
  v_dot2_f32_bf16 v50, v145, v17, v50
  v_dot2_f32_bf16 v50, v146, v18, v50
  v_dot2_f32_bf16 v50, v147, v19, v50
  v_dot2_f32_bf16 v63, v148, v20, 0
  v_dot2_f32_bf16 v63, v149, v21, v63
  v_dot2_f32_bf16 v63, v150, v22, v63
  v_dot2_f32_bf16 v63, v151, v23, v63
  s_xor_b32 s55, s51, 165888
  s_waitcnt vmcnt(4)
  buffer_load_dwordx4 v[244:247], v1, s[28:31], s55 offen nt
  v_dot2_f32_bf16 v51, v152, v16, 0
  v_dot2_f32_bf16 v51, v153, v17, v51
  v_dot2_f32_bf16 v51, v154, v18, v51
  v_dot2_f32_bf16 v51, v155, v19, v51
  v_dot2_f32_bf16 v52, v156, v16, 0
  v_dot2_f32_bf16 v52, v157, v17, v52
  v_dot2_f32_bf16 v52, v158, v18, v52
  v_dot2_f32_bf16 v52, v159, v19, v52
  s_xor_b32 s55, s52, 19456
  s_waitcnt vmcnt(4)
  buffer_load_dwordx4 v[248:251], v1, s[16:19], s55 offen
  v_dot2_f32_bf16 v64, v160, v20, 0
  v_dot2_f32_bf16 v64, v161, v21, v64
  v_dot2_f32_bf16 v64, v162, v22, v64
  v_dot2_f32_bf16 v64, v163, v23, v64
  v_dot2_f32_bf16 v53, v164, v16, 0
  v_dot2_f32_bf16 v53, v165, v17, v53
  v_dot2_f32_bf16 v53, v166, v18, v53
  v_dot2_f32_bf16 v53, v167, v19, v53
  s_xor_b32 s55, s51, 182272
  s_waitcnt vmcnt(4)
  buffer_load_dwordx4 v[252:255], v1, s[28:31], s55 offen nt
  v_dot2_f32_bf16 v54, v168, v16, 0
  v_dot2_f32_bf16 v54, v169, v17, v54
  v_dot2_f32_bf16 v54, v170, v18, v54
  v_dot2_f32_bf16 v54, v171, v19, v54
  v_dot2_f32_bf16 v65, v172, v20, 0
  v_dot2_f32_bf16 v65, v173, v21, v65
  v_dot2_f32_bf16 v65, v174, v22, v65
  v_dot2_f32_bf16 v65, v175, v23, v65
  s_xor_b32 s55, s51, 132096
  s_waitcnt vmcnt(4)
  buffer_load_dwordx4 v[92:95], v1, s[28:31], s55 offen nt
  v_dot2_f32_bf16 v55, v176, v16, 0
  v_dot2_f32_bf16 v55, v177, v17, v55
  v_dot2_f32_bf16 v55, v178, v18, v55
  v_dot2_f32_bf16 v55, v179, v19, v55
  v_dot2_f32_bf16 v56, v180, v16, 0
  v_dot2_f32_bf16 v56, v181, v17, v56
  v_dot2_f32_bf16 v56, v182, v18, v56
  v_dot2_f32_bf16 v56, v183, v19, v56
  s_xor_b32 s55, s52, 33792
  s_waitcnt vmcnt(4)
  buffer_load_dwordx4 v[96:99], v1, s[16:19], s55 offen
  v_dot2_f32_bf16 v66, v184, v20, 0
  v_dot2_f32_bf16 v66, v185, v21, v66
  v_dot2_f32_bf16 v66, v186, v22, v66
  v_dot2_f32_bf16 v66, v187, v23, v66
  v_dot2_f32_bf16 v57, v188, v16, 0
  v_dot2_f32_bf16 v57, v189, v17, v57
  v_dot2_f32_bf16 v57, v190, v18, v57
  v_dot2_f32_bf16 v57, v191, v19, v57
  s_xor_b32 s55, s51, 148480
  s_waitcnt vmcnt(4)
  buffer_load_dwordx4 v[100:103], v1, s[28:31], s55 offen nt
  s_barrier
  v_dot2_f32_bf16 v58, v192, v16, 0
  v_dot2_f32_bf16 v58, v193, v17, v58
  v_dot2_f32_bf16 v58, v194, v18, v58
  v_dot2_f32_bf16 v58, v195, v19, v58
  v_dot2_f32_bf16 v67, v200, v20, 0
  v_dot2_f32_bf16 v67, v201, v21, v67
  v_dot2_f32_bf16 v67, v202, v22, v67
  v_dot2_f32_bf16 v67, v203, v23, v67
  s_xor_b32 s55, s51, 134144
  s_waitcnt vmcnt(4)
  buffer_load_dwordx4 v[104:107], v1, s[28:31], s55 offen nt
  v_dot2_f32_bf16 v59, v204, v16, 0
  v_dot2_f32_bf16 v59, v205, v17, v59
  v_dot2_f32_bf16 v59, v206, v18, v59
  v_dot2_f32_bf16 v59, v207, v19, v59
  v_add_f32_dpp v44, v44, v44 row_ror:8 row_mask:0xf bank_mask:0x3
  v_add_f32_dpp v45, v45, v45 row_ror:8 row_mask:0xf bank_mask:0x3
  v_add_f32_dpp v46, v46, v46 row_ror:8 row_mask:0xf bank_mask:0x3
  v_add_f32_dpp v47, v47, v47 row_ror:8 row_mask:0xf bank_mask:0x3
  v_add_f32_dpp v48, v48, v48 row_ror:8 row_mask:0xf bank_mask:0x3
  v_add_f32_dpp v49, v49, v49 row_ror:8 row_mask:0xf bank_mask:0x3
  v_add_f32_dpp v50, v50, v50 row_ror:8 row_mask:0xf bank_mask:0x3
  v_add_f32_dpp v51, v51, v51 row_ror:8 row_mask:0xf bank_mask:0x3
  v_add_f32_dpp v44, v52, v52 row_ror:8 row_mask:0xf bank_mask:0xc
  v_add_f32_dpp v45, v53, v53 row_ror:8 row_mask:0xf bank_mask:0xc
  v_add_f32_dpp v46, v54, v54 row_ror:8 row_mask:0xf bank_mask:0xc
  v_add_f32_dpp v47, v55, v55 row_ror:8 row_mask:0xf bank_mask:0xc
  v_add_f32_dpp v48, v56, v56 row_ror:8 row_mask:0xf bank_mask:0xc
  v_add_f32_dpp v49, v57, v57 row_ror:8 row_mask:0xf bank_mask:0xc
  v_add_f32_dpp v50, v58, v58 row_ror:8 row_mask:0xf bank_mask:0xc
  v_add_f32_dpp v51, v59, v59 row_ror:8 row_mask:0xf bank_mask:0xc
  v_add_f32_dpp v44, v44, v44 row_half_mirror row_mask:0xf bank_mask:0x5
  v_add_f32_dpp v45, v45, v45 row_half_mirror row_mask:0xf bank_mask:0x5
  v_add_f32_dpp v46, v46, v46 row_half_mirror row_mask:0xf bank_mask:0x5
  v_add_f32_dpp v47, v47, v47 row_half_mirror row_mask:0xf bank_mask:0x5
  v_add_f32_dpp v44, v48, v48 row_half_mirror row_mask:0xf bank_mask:0xa
  v_add_f32_dpp v45, v49, v49 row_half_mirror row_mask:0xf bank_mask:0xa
  v_add_f32_dpp v46, v50, v50 row_half_mirror row_mask:0xf bank_mask:0xa
  v_add_f32_dpp v47, v51, v51 row_half_mirror row_mask:0xf bank_mask:0xa
  v_add_f32_dpp v44, v44, v44 quad_perm:[2,3,0,1] row_mask:0xf bank_mask:0xf
  v_add_f32_dpp v45, v45, v45 quad_perm:[2,3,0,1] row_mask:0xf bank_mask:0xf
  v_add_f32_dpp v46, v46, v46 quad_perm:[2,3,0,1] row_mask:0xf bank_mask:0xf
  v_add_f32_dpp v47, v47, v47 quad_perm:[2,3,0,1] row_mask:0xf bank_mask:0xf
  v_cndmask_b32 v44, v44, v46, s[62:63]
  v_cndmask_b32 v45, v45, v47, s[62:63]
  s_nop 0
  v_add_f32_dpp v44, v44, v44 quad_perm:[1,0,3,2] row_mask:0xf bank_mask:0xf
  v_add_f32_dpp v45, v45, v45 quad_perm:[1,0,3,2] row_mask:0xf bank_mask:0xf
  v_cndmask_b32 v76, v44, v45, s[64:65]
  v_cvt_pk_bf16_f32 v76, 0, v76
  v_mul_f32 v76, s58, v76
  v_cvt_pk_bf16_f32 v76, 0, v76
  v_dot2_f32_bf16 v44, v208, v16, 0
  v_dot2_f32_bf16 v44, v209, v17, v44
  v_dot2_f32_bf16 v44, v210, v18, v44
  v_dot2_f32_bf16 v44, v211, v19, v44
  s_xor_b32 s55, s52, 50176
  s_waitcnt vmcnt(4)
  buffer_load_dwordx4 v[196:199], v1, s[16:19], s55 offen
  v_dot2_f32_bf16 v68, v212, v20, 0
  v_dot2_f32_bf16 v68, v213, v21, v68
  v_dot2_f32_bf16 v68, v214, v22, v68
  v_dot2_f32_bf16 v68, v215, v23, v68
  v_dot2_f32_bf16 v45, v216, v16, 0
  v_dot2_f32_bf16 v45, v217, v17, v45
  v_dot2_f32_bf16 v45, v218, v18, v45
  v_dot2_f32_bf16 v45, v219, v19, v45
  s_xor_b32 s55, s51, 150528
  s_waitcnt vmcnt(4)
  buffer_load_dwordx4 v[108:111], v1, s[28:31], s55 offen nt
  v_dot2_f32_bf16 v46, v220, v16, 0
  v_dot2_f32_bf16 v46, v221, v17, v46
  v_dot2_f32_bf16 v46, v222, v18, v46
  v_dot2_f32_bf16 v46, v223, v19, v46
  v_dot2_f32_bf16 v69, v224, v20, 0
  v_dot2_f32_bf16 v69, v225, v21, v69
  v_dot2_f32_bf16 v69, v226, v22, v69
  v_dot2_f32_bf16 v69, v227, v23, v69
  s_xor_b32 s55, s51, 164864
  s_waitcnt vmcnt(4)
  buffer_load_dwordx4 v[112:115], v1, s[28:31], s55 offen nt
  v_dot2_f32_bf16 v47, v228, v16, 0
  v_dot2_f32_bf16 v47, v229, v17, v47
  v_dot2_f32_bf16 v47, v230, v18, v47
  v_dot2_f32_bf16 v47, v231, v19, v47
  v_dot2_f32_bf16 v48, v232, v16, 0
  v_dot2_f32_bf16 v48, v233, v17, v48
  v_dot2_f32_bf16 v48, v234, v18, v48
  v_dot2_f32_bf16 v48, v235, v19, v48
  s_xor_b32 s55, s52, 35840
  s_waitcnt vmcnt(4)
  buffer_load_dwordx4 v[116:119], v1, s[16:19], s55 offen
  v_dot2_f32_bf16 v70, v236, v20, 0
  v_dot2_f32_bf16 v70, v237, v21, v70
  v_dot2_f32_bf16 v70, v238, v22, v70
  v_dot2_f32_bf16 v70, v239, v23, v70
  v_dot2_f32_bf16 v49, v240, v16, 0
  v_dot2_f32_bf16 v49, v241, v17, v49
  v_dot2_f32_bf16 v49, v242, v18, v49
  v_dot2_f32_bf16 v49, v243, v19, v49
  s_xor_b32 s55, s51, 181248
  s_waitcnt vmcnt(4)
  buffer_load_dwordx4 v[120:123], v1, s[28:31], s55 offen nt
  s_barrier
  v_dot2_f32_bf16 v50, v244, v16, 0
  v_dot2_f32_bf16 v50, v245, v17, v50
  v_dot2_f32_bf16 v50, v246, v18, v50
  v_dot2_f32_bf16 v50, v247, v19, v50
  v_dot2_f32_bf16 v71, v248, v20, 0
  v_dot2_f32_bf16 v71, v249, v21, v71
  v_dot2_f32_bf16 v71, v250, v22, v71
  v_dot2_f32_bf16 v71, v251, v23, v71
  s_xor_b32 s55, s51, 166912
  s_waitcnt vmcnt(4)
  buffer_load_dwordx4 v[124:127], v1, s[28:31], s55 offen nt
  v_dot2_f32_bf16 v51, v252, v16, 0
  v_dot2_f32_bf16 v51, v253, v17, v51
  v_dot2_f32_bf16 v51, v254, v18, v51
  v_dot2_f32_bf16 v51, v255, v19, v51
  v_dot2_f32_bf16 v52, v92, v16, 0
  v_dot2_f32_bf16 v52, v93, v17, v52
  v_dot2_f32_bf16 v52, v94, v18, v52
  v_dot2_f32_bf16 v52, v95, v19, v52
  s_xor_b32 s55, s52, 52224
  s_waitcnt vmcnt(4)
  buffer_load_dwordx4 v[128:131], v1, s[16:19], s55 offen
  v_dot2_f32_bf16 v72, v96, v20, 0
  v_dot2_f32_bf16 v72, v97, v21, v72
  v_dot2_f32_bf16 v72, v98, v22, v72
  v_dot2_f32_bf16 v72, v99, v23, v72
  v_dot2_f32_bf16 v53, v100, v16, 0
  v_dot2_f32_bf16 v53, v101, v17, v53
  v_dot2_f32_bf16 v53, v102, v18, v53
  v_dot2_f32_bf16 v53, v103, v19, v53
  s_xor_b32 s55, s51, 183296
  s_waitcnt vmcnt(4)
  buffer_load_dwordx4 v[132:135], v1, s[28:31], s55 offen nt
  v_dot2_f32_bf16 v54, v104, v16, 0
  v_dot2_f32_bf16 v54, v105, v17, v54
  v_dot2_f32_bf16 v54, v106, v18, v54
  v_dot2_f32_bf16 v54, v107, v19, v54
  v_dot2_f32_bf16 v73, v196, v20, 0
  v_dot2_f32_bf16 v73, v197, v21, v73
  v_dot2_f32_bf16 v73, v198, v22, v73
  v_dot2_f32_bf16 v73, v199, v23, v73
  s_xor_b32 s55, s51, 262144
  s_waitcnt vmcnt(4)
  buffer_load_dwordx4 v[136:139], v1, s[28:31], s55 offen nt
  v_dot2_f32_bf16 v55, v108, v16, 0
  v_dot2_f32_bf16 v55, v109, v17, v55
  v_dot2_f32_bf16 v55, v110, v18, v55
  v_dot2_f32_bf16 v55, v111, v19, v55
  v_dot2_f32_bf16 v56, v112, v16, 0
  v_dot2_f32_bf16 v56, v113, v17, v56
  v_dot2_f32_bf16 v56, v114, v18, v56
  v_dot2_f32_bf16 v56, v115, v19, v56
  s_waitcnt vmcnt(4)
  buffer_load_dwordx4 v[140:143], v1, s[20:23], s52 offen
  v_dot2_f32_bf16 v74, v116, v20, 0
  v_dot2_f32_bf16 v74, v117, v21, v74
  v_dot2_f32_bf16 v74, v118, v22, v74
  v_dot2_f32_bf16 v74, v119, v23, v74
  v_dot2_f32_bf16 v57, v120, v16, 0
  v_dot2_f32_bf16 v57, v121, v17, v57
  v_dot2_f32_bf16 v57, v122, v18, v57
  v_dot2_f32_bf16 v57, v123, v19, v57
  s_xor_b32 s55, s51, 278528
  s_waitcnt vmcnt(4)
  buffer_load_dwordx4 v[144:147], v1, s[28:31], s55 offen nt
  s_barrier
  v_dot2_f32_bf16 v58, v124, v16, 0
  v_dot2_f32_bf16 v58, v125, v17, v58
  v_dot2_f32_bf16 v58, v126, v18, v58
  v_dot2_f32_bf16 v58, v127, v19, v58
  s_xor_b32 s55, s51, 264192
  s_waitcnt vmcnt(4)
  buffer_load_dwordx4 v[148:151], v1, s[28:31], s55 offen nt
  v_dot2_f32_bf16 v75, v128, v20, 0
  v_dot2_f32_bf16 v75, v129, v21, v75
  v_dot2_f32_bf16 v75, v130, v22, v75
  v_dot2_f32_bf16 v75, v131, v23, v75
  v_add_f32_dpp v60, v60, v60 row_ror:8 row_mask:0xf bank_mask:0x3
  v_add_f32_dpp v61, v61, v61 row_ror:8 row_mask:0xf bank_mask:0x3
  v_add_f32_dpp v62, v62, v62 row_ror:8 row_mask:0xf bank_mask:0x3
  v_add_f32_dpp v63, v63, v63 row_ror:8 row_mask:0xf bank_mask:0x3
  v_add_f32_dpp v64, v64, v64 row_ror:8 row_mask:0xf bank_mask:0x3
  v_add_f32_dpp v65, v65, v65 row_ror:8 row_mask:0xf bank_mask:0x3
  v_add_f32_dpp v66, v66, v66 row_ror:8 row_mask:0xf bank_mask:0x3
  v_add_f32_dpp v67, v67, v67 row_ror:8 row_mask:0xf bank_mask:0x3
  v_add_f32_dpp v60, v68, v68 row_ror:8 row_mask:0xf bank_mask:0xc
  v_add_f32_dpp v61, v69, v69 row_ror:8 row_mask:0xf bank_mask:0xc
  v_add_f32_dpp v62, v70, v70 row_ror:8 row_mask:0xf bank_mask:0xc
  v_add_f32_dpp v63, v71, v71 row_ror:8 row_mask:0xf bank_mask:0xc
  v_add_f32_dpp v64, v72, v72 row_ror:8 row_mask:0xf bank_mask:0xc
  v_add_f32_dpp v65, v73, v73 row_ror:8 row_mask:0xf bank_mask:0xc
  v_add_f32_dpp v66, v74, v74 row_ror:8 row_mask:0xf bank_mask:0xc
  v_add_f32_dpp v67, v75, v75 row_ror:8 row_mask:0xf bank_mask:0xc
  v_add_f32_dpp v60, v60, v60 row_half_mirror row_mask:0xf bank_mask:0x5
  v_add_f32_dpp v61, v61, v61 row_half_mirror row_mask:0xf bank_mask:0x5
  v_add_f32_dpp v62, v62, v62 row_half_mirror row_mask:0xf bank_mask:0x5
  v_add_f32_dpp v63, v63, v63 row_half_mirror row_mask:0xf bank_mask:0x5
  v_add_f32_dpp v60, v64, v64 row_half_mirror row_mask:0xf bank_mask:0xa
  v_add_f32_dpp v61, v65, v65 row_half_mirror row_mask:0xf bank_mask:0xa
  v_add_f32_dpp v62, v66, v66 row_half_mirror row_mask:0xf bank_mask:0xa
  v_add_f32_dpp v63, v67, v67 row_half_mirror row_mask:0xf bank_mask:0xa
  v_add_f32_dpp v60, v60, v60 quad_perm:[2,3,0,1] row_mask:0xf bank_mask:0xf
  v_add_f32_dpp v61, v61, v61 quad_perm:[2,3,0,1] row_mask:0xf bank_mask:0xf
  v_add_f32_dpp v62, v62, v62 quad_perm:[2,3,0,1] row_mask:0xf bank_mask:0xf
  v_add_f32_dpp v63, v63, v63 quad_perm:[2,3,0,1] row_mask:0xf bank_mask:0xf
  v_cndmask_b32 v60, v60, v62, s[62:63]
  v_cndmask_b32 v61, v61, v63, s[62:63]
  s_nop 0
  v_add_f32_dpp v60, v60, v60 quad_perm:[1,0,3,2] row_mask:0xf bank_mask:0xf
  v_add_f32_dpp v61, v61, v61 quad_perm:[1,0,3,2] row_mask:0xf bank_mask:0xf
  v_cndmask_b32 v80, v60, v61, s[64:65]
  v_cvt_pk_bf16_f32 v80, 0, v80
  v_mul_f32 v80, s58, v80
  v_cvt_pk_bf16_f32 v80, 0, v80
  v_mov_b32 v13, v80
  s_nop 1
  v_max_f32_dpp v13, v13, v13 row_ror:8 row_mask:0xf bank_mask:0xf
  s_nop 1
  v_max_f32_dpp v13, v13, v13 row_ror:4 row_mask:0xf bank_mask:0xf
  s_nop 1
  v_max_f32_dpp v13, v13, v13 row_ror:2 row_mask:0xf bank_mask:0xf
  s_nop 1
  v_max_f32_dpp v13, v13, v13 row_ror:1 row_mask:0xf bank_mask:0xf
  v_mov_b32 v5, v13
  s_nop 1
  v_permlane16_swap_b32 v13, v5
  v_max_f32 v13, v13, v5
  v_mov_b32 v5, v13
  s_nop 1
  v_permlane32_swap_b32 v13, v5
  v_max_f32 v13, v13, v5
  s_lshl_b32 s7, s3, 2
  v_mov_b32 v5, s7
  ds_write_b32 v5, v13 offset:33536
  s_waitcnt lgkmcnt(0)
  s_barrier
  v_mov_b32 v6, 0
  ds_read_b128 v[60:63], v6 offset:33536
  ds_read_b128 v[64:67], v6 offset:33552
  s_xor_b32 s55, s52, 16384
  s_waitcnt vmcnt(4)
  buffer_load_dwordx4 v[152:155], v1, s[20:23], s55 offen
  s_waitcnt lgkmcnt(0)
  v_max3_f32 v13, v60, v61, v62
  v_max3_f32 v13, v13, v63, v64
  v_max3_f32 v13, v13, v65, v66
  v_max_f32 v13, v13, v67
  v_sub_f32 v80, v80, v13
  v_mul_f32 v80, s59, v80
  v_exp_f32 v80, v80
  s_nop 0
  v_mov_b32 v7, v80
  v_cvt_pk_bf16_f32 v80, v80, v80
  s_nop 0
  v_add_f32_dpp v7, v7, v7 row_ror:8 row_mask:0xf bank_mask:0xf
  s_nop 1
  v_add_f32_dpp v7, v7, v7 row_ror:4 row_mask:0xf bank_mask:0xf
  s_nop 1
  v_add_f32_dpp v7, v7, v7 row_ror:2 row_mask:0xf bank_mask:0xf
  s_nop 1
  v_add_f32_dpp v7, v7, v7 row_ror:1 row_mask:0xf bank_mask:0xf
  v_mov_b32 v8, v7
  s_nop 1
  v_permlane16_swap_b32 v7, v8
  v_add_f32 v7, v7, v8
  v_mov_b32 v8, v7
  s_nop 1
  v_permlane32_swap_b32 v7, v8
  v_add_f32 v7, v7, v8
  s_lshl_b32 s7, s3, 2
  v_mov_b32 v5, s7
  ds_write_b32 v5, v7 offset:33600
  v_dot2_f32_bf16 v59, v132, v16, 0
  v_dot2_f32_bf16 v59, v133, v17, v59
  v_dot2_f32_bf16 v59, v134, v18, v59
  v_dot2_f32_bf16 v59, v135, v19, v59
  v_add_f32_dpp v44, v44, v44 row_ror:8 row_mask:0xf bank_mask:0x3
  v_add_f32_dpp v45, v45, v45 row_ror:8 row_mask:0xf bank_mask:0x3
  v_add_f32_dpp v46, v46, v46 row_ror:8 row_mask:0xf bank_mask:0x3
  v_add_f32_dpp v47, v47, v47 row_ror:8 row_mask:0xf bank_mask:0x3
  v_add_f32_dpp v48, v48, v48 row_ror:8 row_mask:0xf bank_mask:0x3
  v_add_f32_dpp v49, v49, v49 row_ror:8 row_mask:0xf bank_mask:0x3
  v_add_f32_dpp v50, v50, v50 row_ror:8 row_mask:0xf bank_mask:0x3
  v_add_f32_dpp v51, v51, v51 row_ror:8 row_mask:0xf bank_mask:0x3
  v_add_f32_dpp v44, v52, v52 row_ror:8 row_mask:0xf bank_mask:0xc
  v_add_f32_dpp v45, v53, v53 row_ror:8 row_mask:0xf bank_mask:0xc
  v_add_f32_dpp v46, v54, v54 row_ror:8 row_mask:0xf bank_mask:0xc
  v_add_f32_dpp v47, v55, v55 row_ror:8 row_mask:0xf bank_mask:0xc
  v_add_f32_dpp v48, v56, v56 row_ror:8 row_mask:0xf bank_mask:0xc
  v_add_f32_dpp v49, v57, v57 row_ror:8 row_mask:0xf bank_mask:0xc
  v_add_f32_dpp v50, v58, v58 row_ror:8 row_mask:0xf bank_mask:0xc
  v_add_f32_dpp v51, v59, v59 row_ror:8 row_mask:0xf bank_mask:0xc
  v_add_f32_dpp v44, v44, v44 row_half_mirror row_mask:0xf bank_mask:0x5
  v_add_f32_dpp v45, v45, v45 row_half_mirror row_mask:0xf bank_mask:0x5
  v_add_f32_dpp v46, v46, v46 row_half_mirror row_mask:0xf bank_mask:0x5
  v_add_f32_dpp v47, v47, v47 row_half_mirror row_mask:0xf bank_mask:0x5
  v_add_f32_dpp v44, v48, v48 row_half_mirror row_mask:0xf bank_mask:0xa
  v_add_f32_dpp v45, v49, v49 row_half_mirror row_mask:0xf bank_mask:0xa
  v_add_f32_dpp v46, v50, v50 row_half_mirror row_mask:0xf bank_mask:0xa
  v_add_f32_dpp v47, v51, v51 row_half_mirror row_mask:0xf bank_mask:0xa
  v_add_f32_dpp v44, v44, v44 quad_perm:[2,3,0,1] row_mask:0xf bank_mask:0xf
  v_add_f32_dpp v45, v45, v45 quad_perm:[2,3,0,1] row_mask:0xf bank_mask:0xf
  v_add_f32_dpp v46, v46, v46 quad_perm:[2,3,0,1] row_mask:0xf bank_mask:0xf
  v_add_f32_dpp v47, v47, v47 quad_perm:[2,3,0,1] row_mask:0xf bank_mask:0xf
  v_cndmask_b32 v44, v44, v46, s[62:63]
  v_cndmask_b32 v45, v45, v47, s[62:63]
  s_nop 0
  v_add_f32_dpp v44, v44, v44 quad_perm:[1,0,3,2] row_mask:0xf bank_mask:0xf
  v_add_f32_dpp v45, v45, v45 quad_perm:[1,0,3,2] row_mask:0xf bank_mask:0xf
  v_cndmask_b32 v77, v44, v45, s[64:65]
  v_cvt_pk_bf16_f32 v77, 0, v77
  v_mul_f32 v77, s58, v77
  v_cvt_pk_bf16_f32 v77, 0, v77
  s_xor_b32 s55, s51, 280576
  s_waitcnt vmcnt(4)
  buffer_load_dwordx4 v[156:159], v1, s[28:31], s55 offen nt
  v_dot2_f32_bf16 v44, v136, v16, 0
  v_dot2_f32_bf16 v44, v137, v17, v44
  v_dot2_f32_bf16 v44, v138, v18, v44
  v_dot2_f32_bf16 v44, v139, v19, v44
  s_xor_b32 s55, s51, 294912
  s_waitcnt vmcnt(4)
  buffer_load_dwordx4 v[160:163], v1, s[28:31], s55 offen nt
  v_and_b32_dpp v36, v80, v32 row_newbcast:0 row_mask:0xf bank_mask:0xf
  v_and_b32_dpp v37, v80, v33 row_newbcast:0 row_mask:0xf bank_mask:0xf
  v_and_b32_dpp v38, v80, v34 row_newbcast:0 row_mask:0xf bank_mask:0xf
  v_and_b32_dpp v39, v80, v35 row_newbcast:0 row_mask:0xf bank_mask:0xf
  s_nop 1
  v_mfma_f32_16x16x32_bf16 v[28:31], v[36:39], v[140:143], 0
  s_xor_b32 s55, s52, 2048
  s_waitcnt vmcnt(4)
  buffer_load_dwordx4 v[164:167], v1, s[20:23], s55 offen
  v_dot2_f32_bf16 v45, v144, v16, 0
  v_dot2_f32_bf16 v45, v145, v17, v45
  v_dot2_f32_bf16 v45, v146, v18, v45
  v_dot2_f32_bf16 v45, v147, v19, v45
  s_xor_b32 s55, s51, 311296
  s_waitcnt vmcnt(4)
  buffer_load_dwordx4 v[168:171], v1, s[28:31], s55 offen nt
  v_dot2_f32_bf16 v46, v148, v16, 0
  v_dot2_f32_bf16 v46, v149, v17, v46
  v_dot2_f32_bf16 v46, v150, v18, v46
  v_dot2_f32_bf16 v46, v151, v19, v46
  s_xor_b32 s55, s51, 296960
  s_waitcnt vmcnt(4)
  buffer_load_dwordx4 v[172:175], v1, s[28:31], s55 offen nt
  s_barrier
  v_and_b32_dpp v40, v80, v32 row_newbcast:1 row_mask:0xf bank_mask:0xf
  v_and_b32_dpp v41, v80, v33 row_newbcast:1 row_mask:0xf bank_mask:0xf
  v_and_b32_dpp v42, v80, v34 row_newbcast:1 row_mask:0xf bank_mask:0xf
  v_and_b32_dpp v43, v80, v35 row_newbcast:1 row_mask:0xf bank_mask:0xf
  s_nop 1
  v_mfma_f32_16x16x32_bf16 v[28:31], v[40:43], v[152:155], v[28:31]
  s_xor_b32 s55, s52, 18432
  s_waitcnt vmcnt(4)
  buffer_load_dwordx4 v[176:179], v1, s[20:23], s55 offen
  v_dot2_f32_bf16 v47, v156, v16, 0
  v_dot2_f32_bf16 v47, v157, v17, v47
  v_dot2_f32_bf16 v47, v158, v18, v47
  v_dot2_f32_bf16 v47, v159, v19, v47
  s_xor_b32 s55, s51, 313344
  s_waitcnt vmcnt(4)
  buffer_load_dwordx4 v[180:183], v1, s[28:31], s55 offen nt
  v_dot2_f32_bf16 v48, v160, v16, 0
  v_dot2_f32_bf16 v48, v161, v17, v48
  v_dot2_f32_bf16 v48, v162, v18, v48
  v_dot2_f32_bf16 v48, v163, v19, v48
  s_xor_b32 s55, s51, 263168
  s_waitcnt vmcnt(4)
  buffer_load_dwordx4 v[184:187], v1, s[28:31], s55 offen nt
  v_and_b32_dpp v36, v80, v32 row_newbcast:2 row_mask:0xf bank_mask:0xf
  v_and_b32_dpp v37, v80, v33 row_newbcast:2 row_mask:0xf bank_mask:0xf
  v_and_b32_dpp v38, v80, v34 row_newbcast:2 row_mask:0xf bank_mask:0xf
  v_and_b32_dpp v39, v80, v35 row_newbcast:2 row_mask:0xf bank_mask:0xf
  s_nop 1
  v_mfma_f32_16x16x32_bf16 v[28:31], v[36:39], v[164:167], v[28:31]
  s_xor_b32 s55, s52, 32768
  s_waitcnt vmcnt(4)
  buffer_load_dwordx4 v[188:191], v1, s[20:23], s55 offen
  v_dot2_f32_bf16 v49, v168, v16, 0
  v_dot2_f32_bf16 v49, v169, v17, v49
  v_dot2_f32_bf16 v49, v170, v18, v49
  v_dot2_f32_bf16 v49, v171, v19, v49
  s_xor_b32 s55, s51, 279552
  s_waitcnt vmcnt(4)
  buffer_load_dwordx4 v[192:195], v1, s[28:31], s55 offen nt
  v_dot2_f32_bf16 v50, v172, v16, 0
  v_dot2_f32_bf16 v50, v173, v17, v50
  v_dot2_f32_bf16 v50, v174, v18, v50
  v_dot2_f32_bf16 v50, v175, v19, v50
  s_xor_b32 s55, s51, 265216
  s_waitcnt vmcnt(4)
  buffer_load_dwordx4 v[200:203], v1, s[28:31], s55 offen nt
  s_barrier
  v_and_b32_dpp v40, v80, v32 row_newbcast:3 row_mask:0xf bank_mask:0xf
  v_and_b32_dpp v41, v80, v33 row_newbcast:3 row_mask:0xf bank_mask:0xf
  v_and_b32_dpp v42, v80, v34 row_newbcast:3 row_mask:0xf bank_mask:0xf
  v_and_b32_dpp v43, v80, v35 row_newbcast:3 row_mask:0xf bank_mask:0xf
  s_nop 1
  v_mfma_f32_16x16x32_bf16 v[28:31], v[40:43], v[176:179], v[28:31]
  s_xor_b32 s55, s52, 49152
  s_waitcnt vmcnt(4)
  buffer_load_dwordx4 v[204:207], v1, s[20:23], s55 offen
  v_dot2_f32_bf16 v51, v180, v16, 0
  v_dot2_f32_bf16 v51, v181, v17, v51
  v_dot2_f32_bf16 v51, v182, v18, v51
  v_dot2_f32_bf16 v51, v183, v19, v51
  s_xor_b32 s55, s51, 281600
  s_waitcnt vmcnt(4)
  buffer_load_dwordx4 v[208:211], v1, s[28:31], s55 offen nt
  v_dot2_f32_bf16 v52, v184, v16, 0
  v_dot2_f32_bf16 v52, v185, v17, v52
  v_dot2_f32_bf16 v52, v186, v18, v52
  v_dot2_f32_bf16 v52, v187, v19, v52
  s_xor_b32 s55, s51, 295936
  s_waitcnt vmcnt(4)
  buffer_load_dwordx4 v[212:215], v1, s[28:31], s55 offen nt
  v_and_b32_dpp v36, v80, v32 row_newbcast:4 row_mask:0xf bank_mask:0xf
  v_and_b32_dpp v37, v80, v33 row_newbcast:4 row_mask:0xf bank_mask:0xf
  v_and_b32_dpp v38, v80, v34 row_newbcast:4 row_mask:0xf bank_mask:0xf
  v_and_b32_dpp v39, v80, v35 row_newbcast:4 row_mask:0xf bank_mask:0xf
  s_nop 1
  v_mfma_f32_16x16x32_bf16 v[28:31], v[36:39], v[188:191], v[28:31]
  s_xor_b32 s55, s52, 34816
  s_waitcnt vmcnt(4)
  buffer_load_dwordx4 v[216:219], v1, s[20:23], s55 offen
  v_dot2_f32_bf16 v53, v192, v16, 0
  v_dot2_f32_bf16 v53, v193, v17, v53
  v_dot2_f32_bf16 v53, v194, v18, v53
  v_dot2_f32_bf16 v53, v195, v19, v53
  s_xor_b32 s55, s51, 312320
  s_waitcnt vmcnt(4)
  buffer_load_dwordx4 v[220:223], v1, s[28:31], s55 offen nt
  v_dot2_f32_bf16 v54, v200, v16, 0
  v_dot2_f32_bf16 v54, v201, v17, v54
  v_dot2_f32_bf16 v54, v202, v18, v54
  v_dot2_f32_bf16 v54, v203, v19, v54
  s_xor_b32 s55, s51, 297984
  s_waitcnt vmcnt(4)
  buffer_load_dwordx4 v[224:227], v1, s[28:31], s55 offen nt
  s_barrier
  v_and_b32_dpp v40, v80, v32 row_newbcast:5 row_mask:0xf bank_mask:0xf
  v_and_b32_dpp v41, v80, v33 row_newbcast:5 row_mask:0xf bank_mask:0xf
  v_and_b32_dpp v42, v80, v34 row_newbcast:5 row_mask:0xf bank_mask:0xf
  v_and_b32_dpp v43, v80, v35 row_newbcast:5 row_mask:0xf bank_mask:0xf
  s_nop 1
  v_mfma_f32_16x16x32_bf16 v[28:31], v[40:43], v[204:207], v[28:31]
  s_xor_b32 s55, s52, 51200
  s_waitcnt vmcnt(4)
  buffer_load_dwordx4 v[228:231], v1, s[20:23], s55 offen
  v_dot2_f32_bf16 v55, v208, v16, 0
  v_dot2_f32_bf16 v55, v209, v17, v55
  v_dot2_f32_bf16 v55, v210, v18, v55
  v_dot2_f32_bf16 v55, v211, v19, v55
  s_xor_b32 s55, s51, 314368
  s_waitcnt vmcnt(4)
  buffer_load_dwordx4 v[232:235], v1, s[28:31], s55 offen nt
  v_dot2_f32_bf16 v56, v212, v16, 0
  v_dot2_f32_bf16 v56, v213, v17, v56
  v_dot2_f32_bf16 v56, v214, v18, v56
  v_dot2_f32_bf16 v56, v215, v19, v56
  s_xor_b32 s55, s51, 393216
  s_waitcnt vmcnt(4)
  buffer_load_dwordx4 v[236:239], v1, s[28:31], s55 offen nt
  v_and_b32_dpp v36, v80, v32 row_newbcast:6 row_mask:0xf bank_mask:0xf
  v_and_b32_dpp v37, v80, v33 row_newbcast:6 row_mask:0xf bank_mask:0xf
  v_and_b32_dpp v38, v80, v34 row_newbcast:6 row_mask:0xf bank_mask:0xf
  v_and_b32_dpp v39, v80, v35 row_newbcast:6 row_mask:0xf bank_mask:0xf
  s_nop 1
  v_mfma_f32_16x16x32_bf16 v[28:31], v[36:39], v[216:219], v[28:31]
  s_xor_b32 s55, s52, 1024
  s_waitcnt vmcnt(4)
  buffer_load_dwordx4 v[240:243], v1, s[20:23], s55 offen
  v_dot2_f32_bf16 v57, v220, v16, 0
  v_dot2_f32_bf16 v57, v221, v17, v57
  v_dot2_f32_bf16 v57, v222, v18, v57
  v_dot2_f32_bf16 v57, v223, v19, v57
  s_xor_b32 s55, s51, 409600
  s_waitcnt vmcnt(4)
  buffer_load_dwordx4 v[244:247], v1, s[28:31], s55 offen nt
  v_dot2_f32_bf16 v58, v224, v16, 0
  v_dot2_f32_bf16 v58, v225, v17, v58
  v_dot2_f32_bf16 v58, v226, v18, v58
  v_dot2_f32_bf16 v58, v227, v19, v58
  s_xor_b32 s55, s51, 395264
  s_waitcnt vmcnt(4)
  buffer_load_dwordx4 v[248:251], v1, s[28:31], s55 offen nt
  s_barrier
  v_and_b32_dpp v40, v80, v32 row_newbcast:7 row_mask:0xf bank_mask:0xf
  v_and_b32_dpp v41, v80, v33 row_newbcast:7 row_mask:0xf bank_mask:0xf
  v_and_b32_dpp v42, v80, v34 row_newbcast:7 row_mask:0xf bank_mask:0xf
  v_and_b32_dpp v43, v80, v35 row_newbcast:7 row_mask:0xf bank_mask:0xf
  s_nop 1
  v_mfma_f32_16x16x32_bf16 v[28:31], v[40:43], v[228:231], v[28:31]
  s_xor_b32 s55, s52, 17408
  s_waitcnt vmcnt(4)
  buffer_load_dwordx4 v[252:255], v1, s[20:23], s55 offen
  v_dot2_f32_bf16 v59, v232, v16, 0
  v_dot2_f32_bf16 v59, v233, v17, v59
  v_dot2_f32_bf16 v59, v234, v18, v59
  v_dot2_f32_bf16 v59, v235, v19, v59
  v_add_f32_dpp v44, v44, v44 row_ror:8 row_mask:0xf bank_mask:0x3
  v_add_f32_dpp v45, v45, v45 row_ror:8 row_mask:0xf bank_mask:0x3
  v_add_f32_dpp v46, v46, v46 row_ror:8 row_mask:0xf bank_mask:0x3
  v_add_f32_dpp v47, v47, v47 row_ror:8 row_mask:0xf bank_mask:0x3
  v_add_f32_dpp v48, v48, v48 row_ror:8 row_mask:0xf bank_mask:0x3
  v_add_f32_dpp v49, v49, v49 row_ror:8 row_mask:0xf bank_mask:0x3
  v_add_f32_dpp v50, v50, v50 row_ror:8 row_mask:0xf bank_mask:0x3
  v_add_f32_dpp v51, v51, v51 row_ror:8 row_mask:0xf bank_mask:0x3
  v_add_f32_dpp v44, v52, v52 row_ror:8 row_mask:0xf bank_mask:0xc
  v_add_f32_dpp v45, v53, v53 row_ror:8 row_mask:0xf bank_mask:0xc
  v_add_f32_dpp v46, v54, v54 row_ror:8 row_mask:0xf bank_mask:0xc
  v_add_f32_dpp v47, v55, v55 row_ror:8 row_mask:0xf bank_mask:0xc
  v_add_f32_dpp v48, v56, v56 row_ror:8 row_mask:0xf bank_mask:0xc
  v_add_f32_dpp v49, v57, v57 row_ror:8 row_mask:0xf bank_mask:0xc
  v_add_f32_dpp v50, v58, v58 row_ror:8 row_mask:0xf bank_mask:0xc
  v_add_f32_dpp v51, v59, v59 row_ror:8 row_mask:0xf bank_mask:0xc
  v_add_f32_dpp v44, v44, v44 row_half_mirror row_mask:0xf bank_mask:0x5
  v_add_f32_dpp v45, v45, v45 row_half_mirror row_mask:0xf bank_mask:0x5
  v_add_f32_dpp v46, v46, v46 row_half_mirror row_mask:0xf bank_mask:0x5
  v_add_f32_dpp v47, v47, v47 row_half_mirror row_mask:0xf bank_mask:0x5
  v_add_f32_dpp v44, v48, v48 row_half_mirror row_mask:0xf bank_mask:0xa
  v_add_f32_dpp v45, v49, v49 row_half_mirror row_mask:0xf bank_mask:0xa
  v_add_f32_dpp v46, v50, v50 row_half_mirror row_mask:0xf bank_mask:0xa
  v_add_f32_dpp v47, v51, v51 row_half_mirror row_mask:0xf bank_mask:0xa
  v_add_f32_dpp v44, v44, v44 quad_perm:[2,3,0,1] row_mask:0xf bank_mask:0xf
  v_add_f32_dpp v45, v45, v45 quad_perm:[2,3,0,1] row_mask:0xf bank_mask:0xf
  v_add_f32_dpp v46, v46, v46 quad_perm:[2,3,0,1] row_mask:0xf bank_mask:0xf
  v_add_f32_dpp v47, v47, v47 quad_perm:[2,3,0,1] row_mask:0xf bank_mask:0xf
  v_cndmask_b32 v44, v44, v46, s[62:63]
  v_cndmask_b32 v45, v45, v47, s[62:63]
  s_nop 0
  v_add_f32_dpp v44, v44, v44 quad_perm:[1,0,3,2] row_mask:0xf bank_mask:0xf
  v_add_f32_dpp v45, v45, v45 quad_perm:[1,0,3,2] row_mask:0xf bank_mask:0xf
  v_cndmask_b32 v78, v44, v45, s[64:65]
  v_cvt_pk_bf16_f32 v78, 0, v78
  v_mul_f32 v78, s58, v78
  v_cvt_pk_bf16_f32 v78, 0, v78
  s_xor_b32 s55, s51, 411648
  s_waitcnt vmcnt(4)
  buffer_load_dwordx4 v[92:95], v1, s[28:31], s55 offen nt
  v_dot2_f32_bf16 v44, v236, v16, 0
  v_dot2_f32_bf16 v44, v237, v17, v44
  v_dot2_f32_bf16 v44, v238, v18, v44
  v_dot2_f32_bf16 v44, v239, v19, v44
  s_xor_b32 s55, s51, 425984
  s_waitcnt vmcnt(4)
  buffer_load_dwordx4 v[96:99], v1, s[28:31], s55 offen nt
  v_and_b32_dpp v36, v80, v32 row_newbcast:8 row_mask:0xf bank_mask:0xf
  v_and_b32_dpp v37, v80, v33 row_newbcast:8 row_mask:0xf bank_mask:0xf
  v_and_b32_dpp v38, v80, v34 row_newbcast:8 row_mask:0xf bank_mask:0xf
  v_and_b32_dpp v39, v80, v35 row_newbcast:8 row_mask:0xf bank_mask:0xf
  s_nop 1
  v_mfma_f32_16x16x32_bf16 v[28:31], v[36:39], v[240:243], v[28:31]
  s_xor_b32 s55, s52, 3072
  s_waitcnt vmcnt(4)
  buffer_load_dwordx4 v[100:103], v1, s[20:23], s55 offen
  v_dot2_f32_bf16 v45, v244, v16, 0
  v_dot2_f32_bf16 v45, v245, v17, v45
  v_dot2_f32_bf16 v45, v246, v18, v45
  v_dot2_f32_bf16 v45, v247, v19, v45
  s_xor_b32 s55, s51, 442368
  s_waitcnt vmcnt(4)
  buffer_load_dwordx4 v[104:107], v1, s[28:31], s55 offen nt
  v_dot2_f32_bf16 v46, v248, v16, 0
  v_dot2_f32_bf16 v46, v249, v17, v46
  v_dot2_f32_bf16 v46, v250, v18, v46
  v_dot2_f32_bf16 v46, v251, v19, v46
  s_xor_b32 s55, s51, 428032
  s_waitcnt vmcnt(4)
  buffer_load_dwordx4 v[196:199], v1, s[28:31], s55 offen nt
  s_barrier
  v_and_b32_dpp v40, v80, v32 row_newbcast:9 row_mask:0xf bank_mask:0xf
  v_and_b32_dpp v41, v80, v33 row_newbcast:9 row_mask:0xf bank_mask:0xf
  v_and_b32_dpp v42, v80, v34 row_newbcast:9 row_mask:0xf bank_mask:0xf
  v_and_b32_dpp v43, v80, v35 row_newbcast:9 row_mask:0xf bank_mask:0xf
  s_nop 1
  v_mfma_f32_16x16x32_bf16 v[28:31], v[40:43], v[252:255], v[28:31]
  s_xor_b32 s55, s52, 19456
  s_waitcnt vmcnt(4)
  buffer_load_dwordx4 v[108:111], v1, s[20:23], s55 offen
  v_dot2_f32_bf16 v47, v92, v16, 0
  v_dot2_f32_bf16 v47, v93, v17, v47
  v_dot2_f32_bf16 v47, v94, v18, v47
  v_dot2_f32_bf16 v47, v95, v19, v47
  s_xor_b32 s55, s51, 444416
  s_waitcnt vmcnt(4)
  buffer_load_dwordx4 v[112:115], v1, s[28:31], s55 offen nt
  v_dot2_f32_bf16 v48, v96, v16, 0
  v_dot2_f32_bf16 v48, v97, v17, v48
  v_dot2_f32_bf16 v48, v98, v18, v48
  v_dot2_f32_bf16 v48, v99, v19, v48
  s_xor_b32 s55, s51, 394240
  s_waitcnt vmcnt(4)
  buffer_load_dwordx4 v[116:119], v1, s[28:31], s55 offen nt
  v_and_b32_dpp v36, v80, v32 row_newbcast:10 row_mask:0xf bank_mask:0xf
  v_and_b32_dpp v37, v80, v33 row_newbcast:10 row_mask:0xf bank_mask:0xf
  v_and_b32_dpp v38, v80, v34 row_newbcast:10 row_mask:0xf bank_mask:0xf
  v_and_b32_dpp v39, v80, v35 row_newbcast:10 row_mask:0xf bank_mask:0xf
  s_nop 1
  v_mfma_f32_16x16x32_bf16 v[28:31], v[36:39], v[100:103], v[28:31]
  s_xor_b32 s55, s52, 33792
  s_waitcnt vmcnt(4)
  buffer_load_dwordx4 v[120:123], v1, s[20:23], s55 offen
  v_dot2_f32_bf16 v49, v104, v16, 0
  v_dot2_f32_bf16 v49, v105, v17, v49
  v_dot2_f32_bf16 v49, v106, v18, v49
  v_dot2_f32_bf16 v49, v107, v19, v49
  s_xor_b32 s55, s51, 410624
  s_waitcnt vmcnt(4)
  buffer_load_dwordx4 v[124:127], v1, s[28:31], s55 offen nt
  v_dot2_f32_bf16 v50, v196, v16, 0
  v_dot2_f32_bf16 v50, v197, v17, v50
  v_dot2_f32_bf16 v50, v198, v18, v50
  v_dot2_f32_bf16 v50, v199, v19, v50
  s_xor_b32 s55, s51, 396288
  s_waitcnt vmcnt(4)
  buffer_load_dwordx4 v[128:131], v1, s[28:31], s55 offen nt
  s_barrier
  v_and_b32_dpp v40, v80, v32 row_newbcast:11 row_mask:0xf bank_mask:0xf
  v_and_b32_dpp v41, v80, v33 row_newbcast:11 row_mask:0xf bank_mask:0xf
  v_and_b32_dpp v42, v80, v34 row_newbcast:11 row_mask:0xf bank_mask:0xf
  v_and_b32_dpp v43, v80, v35 row_newbcast:11 row_mask:0xf bank_mask:0xf
  s_nop 1
  v_mfma_f32_16x16x32_bf16 v[28:31], v[40:43], v[108:111], v[28:31]
  s_xor_b32 s55, s52, 50176
  s_waitcnt vmcnt(4)
  buffer_load_dwordx4 v[132:135], v1, s[20:23], s55 offen
  v_dot2_f32_bf16 v51, v112, v16, 0
  v_dot2_f32_bf16 v51, v113, v17, v51
  v_dot2_f32_bf16 v51, v114, v18, v51
  v_dot2_f32_bf16 v51, v115, v19, v51
  s_xor_b32 s55, s51, 412672
  s_waitcnt vmcnt(4)
  buffer_load_dwordx4 v[136:139], v1, s[28:31], s55 offen nt
  v_dot2_f32_bf16 v52, v116, v16, 0
  v_dot2_f32_bf16 v52, v117, v17, v52
  v_dot2_f32_bf16 v52, v118, v18, v52
  v_dot2_f32_bf16 v52, v119, v19, v52
  s_xor_b32 s55, s51, 427008
  s_waitcnt vmcnt(4)
  buffer_load_dwordx4 v[140:143], v1, s[28:31], s55 offen nt
  v_and_b32_dpp v36, v80, v32 row_newbcast:12 row_mask:0xf bank_mask:0xf
  v_and_b32_dpp v37, v80, v33 row_newbcast:12 row_mask:0xf bank_mask:0xf
  v_and_b32_dpp v38, v80, v34 row_newbcast:12 row_mask:0xf bank_mask:0xf
  v_and_b32_dpp v39, v80, v35 row_newbcast:12 row_mask:0xf bank_mask:0xf
  s_nop 1
  v_mfma_f32_16x16x32_bf16 v[28:31], v[36:39], v[120:123], v[28:31]
  s_xor_b32 s55, s52, 35840
  s_waitcnt vmcnt(4)
  buffer_load_dwordx4 v[144:147], v1, s[20:23], s55 offen
  v_dot2_f32_bf16 v53, v124, v16, 0
  v_dot2_f32_bf16 v53, v125, v17, v53
  v_dot2_f32_bf16 v53, v126, v18, v53
  v_dot2_f32_bf16 v53, v127, v19, v53
  s_xor_b32 s55, s51, 443392
  s_waitcnt vmcnt(4)
  buffer_load_dwordx4 v[148:151], v1, s[28:31], s55 offen nt
  v_dot2_f32_bf16 v54, v128, v16, 0
  v_dot2_f32_bf16 v54, v129, v17, v54
  v_dot2_f32_bf16 v54, v130, v18, v54
  v_dot2_f32_bf16 v54, v131, v19, v54
  s_xor_b32 s55, s51, 429056
  s_waitcnt vmcnt(4)
  buffer_load_dwordx4 v[152:155], v1, s[28:31], s55 offen nt
  s_barrier
  v_and_b32_dpp v40, v80, v32 row_newbcast:13 row_mask:0xf bank_mask:0xf
  v_and_b32_dpp v41, v80, v33 row_newbcast:13 row_mask:0xf bank_mask:0xf
  v_and_b32_dpp v42, v80, v34 row_newbcast:13 row_mask:0xf bank_mask:0xf
  v_and_b32_dpp v43, v80, v35 row_newbcast:13 row_mask:0xf bank_mask:0xf
  s_nop 1
  v_mfma_f32_16x16x32_bf16 v[28:31], v[40:43], v[132:135], v[28:31]
  s_xor_b32 s55, s52, 52224
  s_waitcnt vmcnt(4)
  buffer_load_dwordx4 v[156:159], v1, s[20:23], s55 offen
  v_dot2_f32_bf16 v55, v136, v16, 0
  v_dot2_f32_bf16 v55, v137, v17, v55
  v_dot2_f32_bf16 v55, v138, v18, v55
  v_dot2_f32_bf16 v55, v139, v19, v55
  s_xor_b32 s55, s51, 445440
  s_waitcnt vmcnt(4)
  buffer_load_dwordx4 v[160:163], v1, s[28:31], s55 offen nt
  v_dot2_f32_bf16 v56, v140, v16, 0
  v_dot2_f32_bf16 v56, v141, v17, v56
  v_dot2_f32_bf16 v56, v142, v18, v56
  v_dot2_f32_bf16 v56, v143, v19, v56
  s_waitcnt vmcnt(4)
  buffer_load_dwordx4 v[164:167], v1, s[32:35], s51 offen nt
  v_and_b32_dpp v36, v80, v32 row_newbcast:14 row_mask:0xf bank_mask:0xf
  v_and_b32_dpp v37, v80, v33 row_newbcast:14 row_mask:0xf bank_mask:0xf
  v_and_b32_dpp v38, v80, v34 row_newbcast:14 row_mask:0xf bank_mask:0xf
  v_and_b32_dpp v39, v80, v35 row_newbcast:14 row_mask:0xf bank_mask:0xf
  s_nop 1
  v_mfma_f32_16x16x32_bf16 v[28:31], v[36:39], v[144:147], v[28:31]
  s_waitcnt vmcnt(4)
  buffer_load_dwordx4 v[168:171], v1, s[24:27], s54 offen
  v_dot2_f32_bf16 v57, v148, v16, 0
  v_dot2_f32_bf16 v57, v149, v17, v57
  v_dot2_f32_bf16 v57, v150, v18, v57
  v_dot2_f32_bf16 v57, v151, v19, v57
  s_xor_b32 s55, s51, 16384
  s_waitcnt vmcnt(4)
  buffer_load_dwordx4 v[172:175], v1, s[32:35], s55 offen nt
  v_dot2_f32_bf16 v58, v152, v16, 0
  v_dot2_f32_bf16 v58, v153, v17, v58
  v_dot2_f32_bf16 v58, v154, v18, v58
  v_dot2_f32_bf16 v58, v155, v19, v58
  s_xor_b32 s55, s51, 2048
  s_waitcnt vmcnt(4)
  buffer_load_dwordx4 v[176:179], v1, s[32:35], s55 offen nt
  s_barrier
  v_and_b32_dpp v40, v80, v32 row_newbcast:15 row_mask:0xf bank_mask:0xf
  v_and_b32_dpp v41, v80, v33 row_newbcast:15 row_mask:0xf bank_mask:0xf
  v_and_b32_dpp v42, v80, v34 row_newbcast:15 row_mask:0xf bank_mask:0xf
  v_and_b32_dpp v43, v80, v35 row_newbcast:15 row_mask:0xf bank_mask:0xf
  s_nop 1
  v_mfma_f32_16x16x32_bf16 v[28:31], v[40:43], v[156:159], v[28:31]
  s_xor_b32 s55, s54, 1024
  s_waitcnt vmcnt(4)
  buffer_load_dwordx4 v[180:183], v1, s[24:27], s55 offen
  v_dot2_f32_bf16 v59, v160, v16, 0
  v_dot2_f32_bf16 v59, v161, v17, v59
  v_dot2_f32_bf16 v59, v162, v18, v59
  v_dot2_f32_bf16 v59, v163, v19, v59
  v_add_f32_dpp v44, v44, v44 row_ror:8 row_mask:0xf bank_mask:0x3
  v_add_f32_dpp v45, v45, v45 row_ror:8 row_mask:0xf bank_mask:0x3
  v_add_f32_dpp v46, v46, v46 row_ror:8 row_mask:0xf bank_mask:0x3
  v_add_f32_dpp v47, v47, v47 row_ror:8 row_mask:0xf bank_mask:0x3
  v_add_f32_dpp v48, v48, v48 row_ror:8 row_mask:0xf bank_mask:0x3
  v_add_f32_dpp v49, v49, v49 row_ror:8 row_mask:0xf bank_mask:0x3
  v_add_f32_dpp v50, v50, v50 row_ror:8 row_mask:0xf bank_mask:0x3
  v_add_f32_dpp v51, v51, v51 row_ror:8 row_mask:0xf bank_mask:0x3
  v_add_f32_dpp v44, v52, v52 row_ror:8 row_mask:0xf bank_mask:0xc
  v_add_f32_dpp v45, v53, v53 row_ror:8 row_mask:0xf bank_mask:0xc
  v_add_f32_dpp v46, v54, v54 row_ror:8 row_mask:0xf bank_mask:0xc
  v_add_f32_dpp v47, v55, v55 row_ror:8 row_mask:0xf bank_mask:0xc
  v_add_f32_dpp v48, v56, v56 row_ror:8 row_mask:0xf bank_mask:0xc
  v_add_f32_dpp v49, v57, v57 row_ror:8 row_mask:0xf bank_mask:0xc
  v_add_f32_dpp v50, v58, v58 row_ror:8 row_mask:0xf bank_mask:0xc
  v_add_f32_dpp v51, v59, v59 row_ror:8 row_mask:0xf bank_mask:0xc
  v_add_f32_dpp v44, v44, v44 row_half_mirror row_mask:0xf bank_mask:0x5
  v_add_f32_dpp v45, v45, v45 row_half_mirror row_mask:0xf bank_mask:0x5
  v_add_f32_dpp v46, v46, v46 row_half_mirror row_mask:0xf bank_mask:0x5
  v_add_f32_dpp v47, v47, v47 row_half_mirror row_mask:0xf bank_mask:0x5
  v_add_f32_dpp v44, v48, v48 row_half_mirror row_mask:0xf bank_mask:0xa
  v_add_f32_dpp v45, v49, v49 row_half_mirror row_mask:0xf bank_mask:0xa
  v_add_f32_dpp v46, v50, v50 row_half_mirror row_mask:0xf bank_mask:0xa
  v_add_f32_dpp v47, v51, v51 row_half_mirror row_mask:0xf bank_mask:0xa
  v_add_f32_dpp v44, v44, v44 quad_perm:[2,3,0,1] row_mask:0xf bank_mask:0xf
  v_add_f32_dpp v45, v45, v45 quad_perm:[2,3,0,1] row_mask:0xf bank_mask:0xf
  v_add_f32_dpp v46, v46, v46 quad_perm:[2,3,0,1] row_mask:0xf bank_mask:0xf
  v_add_f32_dpp v47, v47, v47 quad_perm:[2,3,0,1] row_mask:0xf bank_mask:0xf
  v_cndmask_b32 v44, v44, v46, s[62:63]
  v_cndmask_b32 v45, v45, v47, s[62:63]
  s_nop 0
  v_add_f32_dpp v44, v44, v44 quad_perm:[1,0,3,2] row_mask:0xf bank_mask:0xf
  v_add_f32_dpp v45, v45, v45 quad_perm:[1,0,3,2] row_mask:0xf bank_mask:0xf
  v_cndmask_b32 v79, v44, v45, s[64:65]
  v_cvt_pk_bf16_f32 v79, 0, v79
  v_mul_f32 v79, s58, v79
  v_cvt_pk_bf16_f32 v79, 0, v79
  v_max3_f32 v14, v76, v77, v78
  v_max_f32 v14, v14, v79
  s_nop 1
  v_max_f32_dpp v14, v14, v14 row_ror:8 row_mask:0xf bank_mask:0xf
  s_nop 1
  v_max_f32_dpp v14, v14, v14 row_ror:4 row_mask:0xf bank_mask:0xf
  s_nop 1
  v_max_f32_dpp v14, v14, v14 row_ror:2 row_mask:0xf bank_mask:0xf
  s_nop 1
  v_max_f32_dpp v14, v14, v14 row_ror:1 row_mask:0xf bank_mask:0xf
  v_mov_b32 v5, v14
  s_nop 1
  v_permlane16_swap_b32 v14, v5
  v_max_f32 v14, v14, v5
  v_mov_b32 v5, v14
  s_nop 1
  v_permlane32_swap_b32 v14, v5
  v_max_f32 v14, v14, v5
  s_lshl_b32 s7, s3, 2
  v_mov_b32 v5, s7
  ds_write_b32 v5, v14 offset:33568
  s_mov_b64 exec, 0xffffffff
  ds_write_b128 v3, v[28:31] offset:12288
  s_mov_b64 exec, -1
  s_waitcnt lgkmcnt(0)
  s_barrier
  v_mov_b32 v6, 0
  ds_read_b128 v[60:63], v6 offset:33568
  ds_read_b128 v[64:67], v6 offset:33584
  ds_read2_b32 v[44:45], v4 offset0:0 offset1:132
  s_xor_b32 s55, s51, 18432
  s_waitcnt vmcnt(4)
  buffer_load_dwordx4 v[184:187], v1, s[32:35], s55 offen nt
  s_waitcnt lgkmcnt(0)
  v_max3_f32 v14, v60, v61, v62
  v_max3_f32 v14, v14, v63, v64
  v_max3_f32 v14, v14, v65, v66
  v_max_f32 v14, v14, v67
  v_sub_f32 v76, v76, v14
  v_sub_f32 v77, v77, v14
  v_sub_f32 v78, v78, v14
  v_sub_f32 v79, v79, v14
  v_mul_f32 v76, s59, v76
  v_mul_f32 v77, s59, v77
  v_mul_f32 v78, s59, v78
  v_mul_f32 v79, s59, v79
  v_exp_f32 v76, v76
  v_exp_f32 v77, v77
  v_exp_f32 v78, v78
  v_exp_f32 v79, v79
  v_add_f32 v7, v76, v77
  v_add_f32 v8, v78, v79
  v_add_f32 v7, v7, v8
  v_cvt_pk_bf16_f32 v76, v76, v76
  v_cvt_pk_bf16_f32 v77, v77, v77
  v_cvt_pk_bf16_f32 v78, v78, v78
  v_cvt_pk_bf16_f32 v79, v79, v79
  v_add_f32_dpp v7, v7, v7 row_ror:8 row_mask:0xf bank_mask:0xf
  s_nop 1
  v_add_f32_dpp v7, v7, v7 row_ror:4 row_mask:0xf bank_mask:0xf
  s_nop 1
  v_add_f32_dpp v7, v7, v7 row_ror:2 row_mask:0xf bank_mask:0xf
  s_nop 1
  v_add_f32_dpp v7, v7, v7 row_ror:1 row_mask:0xf bank_mask:0xf
  v_mov_b32 v8, v7
  s_nop 1
  v_permlane16_swap_b32 v7, v8
  v_add_f32 v7, v7, v8
  v_mov_b32 v8, v7
  s_nop 1
  v_permlane32_swap_b32 v7, v8
  v_add_f32 v7, v7, v8
  s_lshl_b32 s7, s3, 2
  v_mov_b32 v5, s7
  ds_write_b32 v5, v7 offset:33632
  v_add_f32 v44, v44, v45
  s_nop 1
  v_add_f32_dpp v44, v44, v44 quad_perm:[1,0,3,2] row_mask:0xf bank_mask:0xf
  s_nop 1
  v_add_f32_dpp v44, v44, v44 quad_perm:[2,3,0,1] row_mask:0xf bank_mask:0xf
  v_cvt_pk_bf16_f32 v81, v44, v44
  v_and_b32 v86, v81, v88
  v_and_b32 v87, v81, v89
  v_and_b32_dpp v36, v76, v32 row_newbcast:0 row_mask:0xf bank_mask:0xf
  v_and_b32_dpp v37, v76, v33 row_newbcast:0 row_mask:0xf bank_mask:0xf
  v_and_b32_dpp v38, v76, v34 row_newbcast:0 row_mask:0xf bank_mask:0xf
  v_and_b32_dpp v39, v76, v35 row_newbcast:0 row_mask:0xf bank_mask:0xf
  s_nop 1
  v_mfma_f32_16x16x32_bf16 v[24:27], v[36:39], v[164:167], 0
  s_xor_b32 s55, s51, 32768
  s_waitcnt vmcnt(4)
  buffer_load_dwordx4 v[188:191], v1, s[32:35], s55 offen nt
  v_mfma_f32_4x4x4_16b_bf16 v[28:31], v[86:87], v[168:169], 0 cbsz:4 abid:0
  v_mfma_f32_4x4x4_16b_bf16 v[72:75], v[86:87], v[170:171], 0 cbsz:4 abid:0
  s_xor_b32 s55, s54, 2048
  s_waitcnt vmcnt(4)
  buffer_load_dwordx4 v[192:195], v1, s[24:27], s55 offen
  v_and_b32_dpp v40, v76, v32 row_newbcast:1 row_mask:0xf bank_mask:0xf
  v_and_b32_dpp v41, v76, v33 row_newbcast:1 row_mask:0xf bank_mask:0xf
  v_and_b32_dpp v42, v76, v34 row_newbcast:1 row_mask:0xf bank_mask:0xf
  v_and_b32_dpp v43, v76, v35 row_newbcast:1 row_mask:0xf bank_mask:0xf
  s_nop 1
  v_mfma_f32_16x16x32_bf16 v[24:27], v[40:43], v[172:175], v[24:27]
  s_xor_b32 s55, s51, 49152
  s_waitcnt vmcnt(4)
  buffer_load_dwordx4 v[200:203], v1, s[32:35], s55 offen nt
  v_and_b32_dpp v36, v76, v32 row_newbcast:2 row_mask:0xf bank_mask:0xf
  v_and_b32_dpp v37, v76, v33 row_newbcast:2 row_mask:0xf bank_mask:0xf
  v_and_b32_dpp v38, v76, v34 row_newbcast:2 row_mask:0xf bank_mask:0xf
  v_and_b32_dpp v39, v76, v35 row_newbcast:2 row_mask:0xf bank_mask:0xf
  s_nop 1
  v_mfma_f32_16x16x32_bf16 v[24:27], v[36:39], v[176:179], v[24:27]
  s_xor_b32 s55, s51, 34816
  s_waitcnt vmcnt(4)
  buffer_load_dwordx4 v[204:207], v1, s[32:35], s55 offen nt
  v_mfma_f32_4x4x4_16b_bf16 v[28:31], v[86:87], v[180:181], v[28:31] cbsz:4 abid:1
  v_mfma_f32_4x4x4_16b_bf16 v[72:75], v[86:87], v[182:183], v[72:75] cbsz:4 abid:1
  s_xor_b32 s55, s54, 3072
  s_waitcnt vmcnt(4)
  buffer_load_dwordx4 v[208:211], v1, s[24:27], s55 offen
  s_barrier
  v_and_b32_dpp v40, v76, v32 row_newbcast:3 row_mask:0xf bank_mask:0xf
  v_and_b32_dpp v41, v76, v33 row_newbcast:3 row_mask:0xf bank_mask:0xf
  v_and_b32_dpp v42, v76, v34 row_newbcast:3 row_mask:0xf bank_mask:0xf
  v_and_b32_dpp v43, v76, v35 row_newbcast:3 row_mask:0xf bank_mask:0xf
  s_nop 1
  v_mfma_f32_16x16x32_bf16 v[24:27], v[40:43], v[184:187], v[24:27]
  s_xor_b32 s55, s51, 51200
  s_waitcnt vmcnt(4)
  buffer_load_dwordx4 v[212:215], v1, s[32:35], s55 offen nt
  v_and_b32_dpp v36, v76, v32 row_newbcast:4 row_mask:0xf bank_mask:0xf
  v_and_b32_dpp v37, v76, v33 row_newbcast:4 row_mask:0xf bank_mask:0xf
  v_and_b32_dpp v38, v76, v34 row_newbcast:4 row_mask:0xf bank_mask:0xf
  v_and_b32_dpp v39, v76, v35 row_newbcast:4 row_mask:0xf bank_mask:0xf
  s_nop 1
  v_mfma_f32_16x16x32_bf16 v[24:27], v[36:39], v[188:191], v[24:27]
  s_xor_b32 s55, s51, 1024
  s_waitcnt vmcnt(4)
  buffer_load_dwordx4 v[216:219], v1, s[32:35], s55 offen nt
  v_mfma_f32_4x4x4_16b_bf16 v[28:31], v[86:87], v[192:193], v[28:31] cbsz:4 abid:2
  v_mfma_f32_4x4x4_16b_bf16 v[72:75], v[86:87], v[194:195], v[72:75] cbsz:4 abid:2
  s_xor_b32 s55, s54, 4096
  s_waitcnt vmcnt(4)
  buffer_load_dwordx4 v[220:223], v1, s[24:27], s55 offen
  v_and_b32_dpp v40, v76, v32 row_newbcast:5 row_mask:0xf bank_mask:0xf
  v_and_b32_dpp v41, v76, v33 row_newbcast:5 row_mask:0xf bank_mask:0xf
  v_and_b32_dpp v42, v76, v34 row_newbcast:5 row_mask:0xf bank_mask:0xf
  v_and_b32_dpp v43, v76, v35 row_newbcast:5 row_mask:0xf bank_mask:0xf
  s_nop 1
  v_mfma_f32_16x16x32_bf16 v[24:27], v[40:43], v[200:203], v[24:27]
  s_xor_b32 s55, s51, 17408
  s_waitcnt vmcnt(4)
  buffer_load_dwordx4 v[224:227], v1, s[32:35], s55 offen nt
  v_and_b32_dpp v36, v76, v32 row_newbcast:6 row_mask:0xf bank_mask:0xf
  v_and_b32_dpp v37, v76, v33 row_newbcast:6 row_mask:0xf bank_mask:0xf
  v_and_b32_dpp v38, v76, v34 row_newbcast:6 row_mask:0xf bank_mask:0xf
  v_and_b32_dpp v39, v76, v35 row_newbcast:6 row_mask:0xf bank_mask:0xf
  s_nop 1
  v_mfma_f32_16x16x32_bf16 v[24:27], v[36:39], v[204:207], v[24:27]
  s_xor_b32 s55, s51, 3072
  s_waitcnt vmcnt(4)
  buffer_load_dwordx4 v[228:231], v1, s[32:35], s55 offen nt
  v_mfma_f32_4x4x4_16b_bf16 v[28:31], v[86:87], v[208:209], v[28:31] cbsz:4 abid:3
  v_mfma_f32_4x4x4_16b_bf16 v[72:75], v[86:87], v[210:211], v[72:75] cbsz:4 abid:3
  s_xor_b32 s55, s54, 5120
  s_waitcnt vmcnt(4)
  buffer_load_dwordx4 v[232:235], v1, s[24:27], s55 offen
  s_barrier
  v_and_b32_dpp v40, v76, v32 row_newbcast:7 row_mask:0xf bank_mask:0xf
  v_and_b32_dpp v41, v76, v33 row_newbcast:7 row_mask:0xf bank_mask:0xf
  v_and_b32_dpp v42, v76, v34 row_newbcast:7 row_mask:0xf bank_mask:0xf
  v_and_b32_dpp v43, v76, v35 row_newbcast:7 row_mask:0xf bank_mask:0xf
  s_nop 1
  v_mfma_f32_16x16x32_bf16 v[24:27], v[40:43], v[212:215], v[24:27]
  s_xor_b32 s55, s51, 19456
  s_waitcnt vmcnt(4)
  buffer_load_dwordx4 v[236:239], v1, s[32:35], s55 offen nt
  v_and_b32_dpp v36, v76, v32 row_newbcast:8 row_mask:0xf bank_mask:0xf
  v_and_b32_dpp v37, v76, v33 row_newbcast:8 row_mask:0xf bank_mask:0xf
  v_and_b32_dpp v38, v76, v34 row_newbcast:8 row_mask:0xf bank_mask:0xf
  v_and_b32_dpp v39, v76, v35 row_newbcast:8 row_mask:0xf bank_mask:0xf
  s_nop 1
  v_mfma_f32_16x16x32_bf16 v[24:27], v[36:39], v[216:219], v[24:27]
  s_xor_b32 s55, s51, 33792
  s_waitcnt vmcnt(4)
  buffer_load_dwordx4 v[240:243], v1, s[32:35], s55 offen nt
  v_mfma_f32_4x4x4_16b_bf16 v[28:31], v[86:87], v[220:221], v[28:31] cbsz:4 abid:4
  v_mfma_f32_4x4x4_16b_bf16 v[72:75], v[86:87], v[222:223], v[72:75] cbsz:4 abid:4
  s_xor_b32 s55, s54, 6144
  s_waitcnt vmcnt(4)
  buffer_load_dwordx4 v[244:247], v1, s[24:27], s55 offen
  v_and_b32_dpp v40, v76, v32 row_newbcast:9 row_mask:0xf bank_mask:0xf
  v_and_b32_dpp v41, v76, v33 row_newbcast:9 row_mask:0xf bank_mask:0xf
  v_and_b32_dpp v42, v76, v34 row_newbcast:9 row_mask:0xf bank_mask:0xf
  v_and_b32_dpp v43, v76, v35 row_newbcast:9 row_mask:0xf bank_mask:0xf
  s_nop 1
  v_mfma_f32_16x16x32_bf16 v[24:27], v[40:43], v[224:227], v[24:27]
  s_xor_b32 s55, s51, 50176
  s_waitcnt vmcnt(4)
  buffer_load_dwordx4 v[248:251], v1, s[32:35], s55 offen nt
  v_and_b32_dpp v36, v76, v32 row_newbcast:10 row_mask:0xf bank_mask:0xf
  v_and_b32_dpp v37, v76, v33 row_newbcast:10 row_mask:0xf bank_mask:0xf
  v_and_b32_dpp v38, v76, v34 row_newbcast:10 row_mask:0xf bank_mask:0xf
  v_and_b32_dpp v39, v76, v35 row_newbcast:10 row_mask:0xf bank_mask:0xf
  s_nop 1
  v_mfma_f32_16x16x32_bf16 v[24:27], v[36:39], v[228:231], v[24:27]
  s_xor_b32 s55, s51, 35840
  s_waitcnt vmcnt(4)
  buffer_load_dwordx4 v[252:255], v1, s[32:35], s55 offen nt
  v_mfma_f32_4x4x4_16b_bf16 v[28:31], v[86:87], v[232:233], v[28:31] cbsz:4 abid:5
  v_mfma_f32_4x4x4_16b_bf16 v[72:75], v[86:87], v[234:235], v[72:75] cbsz:4 abid:5
  s_xor_b32 s55, s54, 7168
  s_waitcnt vmcnt(4)
  buffer_load_dwordx4 v[92:95], v1, s[24:27], s55 offen
  s_barrier
  v_and_b32_dpp v40, v76, v32 row_newbcast:11 row_mask:0xf bank_mask:0xf
  v_and_b32_dpp v41, v76, v33 row_newbcast:11 row_mask:0xf bank_mask:0xf
  v_and_b32_dpp v42, v76, v34 row_newbcast:11 row_mask:0xf bank_mask:0xf
  v_and_b32_dpp v43, v76, v35 row_newbcast:11 row_mask:0xf bank_mask:0xf
  s_nop 1
  v_mfma_f32_16x16x32_bf16 v[24:27], v[40:43], v[236:239], v[24:27]
  s_xor_b32 s55, s51, 52224
  s_waitcnt vmcnt(4)
  buffer_load_dwordx4 v[96:99], v1, s[32:35], s55 offen nt
  v_and_b32_dpp v36, v76, v32 row_newbcast:12 row_mask:0xf bank_mask:0xf
  v_and_b32_dpp v37, v76, v33 row_newbcast:12 row_mask:0xf bank_mask:0xf
  v_and_b32_dpp v38, v76, v34 row_newbcast:12 row_mask:0xf bank_mask:0xf
  v_and_b32_dpp v39, v76, v35 row_newbcast:12 row_mask:0xf bank_mask:0xf
  s_nop 1
  v_mfma_f32_16x16x32_bf16 v[24:27], v[36:39], v[240:243], v[24:27]
  s_xor_b32 s55, s51, 131072
  s_waitcnt vmcnt(4)
  buffer_load_dwordx4 v[100:103], v1, s[32:35], s55 offen nt
  v_mfma_f32_4x4x4_16b_bf16 v[28:31], v[86:87], v[244:245], v[28:31] cbsz:4 abid:6
  v_mfma_f32_4x4x4_16b_bf16 v[72:75], v[86:87], v[246:247], v[72:75] cbsz:4 abid:6
  s_xor_b32 s55, s54, 8192
  s_waitcnt vmcnt(4)
  buffer_load_dwordx4 v[104:107], v1, s[24:27], s55 offen
  v_and_b32_dpp v40, v76, v32 row_newbcast:13 row_mask:0xf bank_mask:0xf
  v_and_b32_dpp v41, v76, v33 row_newbcast:13 row_mask:0xf bank_mask:0xf
  v_and_b32_dpp v42, v76, v34 row_newbcast:13 row_mask:0xf bank_mask:0xf
  v_and_b32_dpp v43, v76, v35 row_newbcast:13 row_mask:0xf bank_mask:0xf
  s_nop 1
  v_mfma_f32_16x16x32_bf16 v[24:27], v[40:43], v[248:251], v[24:27]
  s_xor_b32 s55, s51, 147456
  s_waitcnt vmcnt(4)
  buffer_load_dwordx4 v[196:199], v1, s[32:35], s55 offen nt
  v_and_b32_dpp v36, v76, v32 row_newbcast:14 row_mask:0xf bank_mask:0xf
  v_and_b32_dpp v37, v76, v33 row_newbcast:14 row_mask:0xf bank_mask:0xf
  v_and_b32_dpp v38, v76, v34 row_newbcast:14 row_mask:0xf bank_mask:0xf
  v_and_b32_dpp v39, v76, v35 row_newbcast:14 row_mask:0xf bank_mask:0xf
  s_nop 1
  v_mfma_f32_16x16x32_bf16 v[24:27], v[36:39], v[252:255], v[24:27]
  s_xor_b32 s55, s51, 133120
  s_waitcnt vmcnt(4)
  buffer_load_dwordx4 v[108:111], v1, s[32:35], s55 offen nt
  v_mfma_f32_4x4x4_16b_bf16 v[28:31], v[86:87], v[92:93], v[28:31] cbsz:4 abid:7
  v_mfma_f32_4x4x4_16b_bf16 v[72:75], v[86:87], v[94:95], v[72:75] cbsz:4 abid:7
  s_xor_b32 s55, s54, 9216
  s_waitcnt vmcnt(4)
  buffer_load_dwordx4 v[112:115], v1, s[24:27], s55 offen
  s_barrier
  v_and_b32_dpp v40, v76, v32 row_newbcast:15 row_mask:0xf bank_mask:0xf
  v_and_b32_dpp v41, v76, v33 row_newbcast:15 row_mask:0xf bank_mask:0xf
  v_and_b32_dpp v42, v76, v34 row_newbcast:15 row_mask:0xf bank_mask:0xf
  v_and_b32_dpp v43, v76, v35 row_newbcast:15 row_mask:0xf bank_mask:0xf
  s_nop 1
  v_mfma_f32_16x16x32_bf16 v[24:27], v[40:43], v[96:99], v[24:27]
  s_xor_b32 s55, s51, 149504
  s_waitcnt vmcnt(4)
  buffer_load_dwordx4 v[116:119], v1, s[32:35], s55 offen nt
  v_and_b32_dpp v36, v77, v32 row_newbcast:0 row_mask:0xf bank_mask:0xf
  v_and_b32_dpp v37, v77, v33 row_newbcast:0 row_mask:0xf bank_mask:0xf
  v_and_b32_dpp v38, v77, v34 row_newbcast:0 row_mask:0xf bank_mask:0xf
  v_and_b32_dpp v39, v77, v35 row_newbcast:0 row_mask:0xf bank_mask:0xf
  s_nop 1
  v_mfma_f32_16x16x32_bf16 v[24:27], v[36:39], v[100:103], v[24:27]
  s_xor_b32 s55, s51, 163840
  s_waitcnt vmcnt(4)
  buffer_load_dwordx4 v[120:123], v1, s[32:35], s55 offen nt
  v_mfma_f32_4x4x4_16b_bf16 v[28:31], v[86:87], v[104:105], v[28:31] cbsz:4 abid:8
  v_mfma_f32_4x4x4_16b_bf16 v[72:75], v[86:87], v[106:107], v[72:75] cbsz:4 abid:8
  s_xor_b32 s55, s54, 10240
  s_waitcnt vmcnt(4)
  buffer_load_dwordx4 v[124:127], v1, s[24:27], s55 offen
  v_and_b32_dpp v40, v77, v32 row_newbcast:1 row_mask:0xf bank_mask:0xf
  v_and_b32_dpp v41, v77, v33 row_newbcast:1 row_mask:0xf bank_mask:0xf
  v_and_b32_dpp v42, v77, v34 row_newbcast:1 row_mask:0xf bank_mask:0xf
  v_and_b32_dpp v43, v77, v35 row_newbcast:1 row_mask:0xf bank_mask:0xf
  s_nop 1
  v_mfma_f32_16x16x32_bf16 v[24:27], v[40:43], v[196:199], v[24:27]
  s_xor_b32 s55, s51, 180224
  s_waitcnt vmcnt(4)
  buffer_load_dwordx4 v[128:131], v1, s[32:35], s55 offen nt
  v_and_b32_dpp v36, v77, v32 row_newbcast:2 row_mask:0xf bank_mask:0xf
  v_and_b32_dpp v37, v77, v33 row_newbcast:2 row_mask:0xf bank_mask:0xf
  v_and_b32_dpp v38, v77, v34 row_newbcast:2 row_mask:0xf bank_mask:0xf
  v_and_b32_dpp v39, v77, v35 row_newbcast:2 row_mask:0xf bank_mask:0xf
  s_nop 1
  v_mfma_f32_16x16x32_bf16 v[24:27], v[36:39], v[108:111], v[24:27]
  s_xor_b32 s55, s51, 165888
  s_waitcnt vmcnt(4)
  buffer_load_dwordx4 v[132:135], v1, s[32:35], s55 offen nt
  v_mfma_f32_4x4x4_16b_bf16 v[28:31], v[86:87], v[112:113], v[28:31] cbsz:4 abid:9
  v_mfma_f32_4x4x4_16b_bf16 v[72:75], v[86:87], v[114:115], v[72:75] cbsz:4 abid:9
  s_xor_b32 s55, s54, 11264
  s_waitcnt vmcnt(4)
  buffer_load_dwordx4 v[136:139], v1, s[24:27], s55 offen
  s_barrier
  v_and_b32_dpp v40, v77, v32 row_newbcast:3 row_mask:0xf bank_mask:0xf
  v_and_b32_dpp v41, v77, v33 row_newbcast:3 row_mask:0xf bank_mask:0xf
  v_and_b32_dpp v42, v77, v34 row_newbcast:3 row_mask:0xf bank_mask:0xf
  v_and_b32_dpp v43, v77, v35 row_newbcast:3 row_mask:0xf bank_mask:0xf
  s_nop 1
  v_mfma_f32_16x16x32_bf16 v[24:27], v[40:43], v[116:119], v[24:27]
  s_xor_b32 s55, s51, 182272
  s_waitcnt vmcnt(4)
  buffer_load_dwordx4 v[140:143], v1, s[32:35], s55 offen nt
  v_and_b32_dpp v36, v77, v32 row_newbcast:4 row_mask:0xf bank_mask:0xf
  v_and_b32_dpp v37, v77, v33 row_newbcast:4 row_mask:0xf bank_mask:0xf
  v_and_b32_dpp v38, v77, v34 row_newbcast:4 row_mask:0xf bank_mask:0xf
  v_and_b32_dpp v39, v77, v35 row_newbcast:4 row_mask:0xf bank_mask:0xf
  s_nop 1
  v_mfma_f32_16x16x32_bf16 v[24:27], v[36:39], v[120:123], v[24:27]
  s_xor_b32 s55, s51, 132096
  s_waitcnt vmcnt(4)
  buffer_load_dwordx4 v[144:147], v1, s[32:35], s55 offen nt
  v_mfma_f32_4x4x4_16b_bf16 v[28:31], v[86:87], v[124:125], v[28:31] cbsz:4 abid:10
  v_mfma_f32_4x4x4_16b_bf16 v[72:75], v[86:87], v[126:127], v[72:75] cbsz:4 abid:10
  s_xor_b32 s55, s54, 12288
  s_waitcnt vmcnt(4)
  buffer_load_dwordx4 v[148:151], v1, s[24:27], s55 offen
  v_and_b32_dpp v40, v77, v32 row_newbcast:5 row_mask:0xf bank_mask:0xf
  v_and_b32_dpp v41, v77, v33 row_newbcast:5 row_mask:0xf bank_mask:0xf
  v_and_b32_dpp v42, v77, v34 row_newbcast:5 row_mask:0xf bank_mask:0xf
  v_and_b32_dpp v43, v77, v35 row_newbcast:5 row_mask:0xf bank_mask:0xf
  s_nop 1
  v_mfma_f32_16x16x32_bf16 v[24:27], v[40:43], v[128:131], v[24:27]
  s_xor_b32 s55, s51, 148480
  s_waitcnt vmcnt(4)
  buffer_load_dwordx4 v[152:155], v1, s[32:35], s55 offen nt
  v_and_b32_dpp v36, v77, v32 row_newbcast:6 row_mask:0xf bank_mask:0xf
  v_and_b32_dpp v37, v77, v33 row_newbcast:6 row_mask:0xf bank_mask:0xf
  v_and_b32_dpp v38, v77, v34 row_newbcast:6 row_mask:0xf bank_mask:0xf
  v_and_b32_dpp v39, v77, v35 row_newbcast:6 row_mask:0xf bank_mask:0xf
  s_nop 1
  v_mfma_f32_16x16x32_bf16 v[24:27], v[36:39], v[132:135], v[24:27]
  s_xor_b32 s55, s51, 134144
  s_waitcnt vmcnt(4)
  buffer_load_dwordx4 v[156:159], v1, s[32:35], s55 offen nt
  v_mfma_f32_4x4x4_16b_bf16 v[28:31], v[86:87], v[136:137], v[28:31] cbsz:4 abid:11
  v_mfma_f32_4x4x4_16b_bf16 v[72:75], v[86:87], v[138:139], v[72:75] cbsz:4 abid:11
  s_xor_b32 s55, s54, 13312
  s_waitcnt vmcnt(4)
  buffer_load_dwordx4 v[160:163], v1, s[24:27], s55 offen
  s_barrier
  v_and_b32_dpp v40, v77, v32 row_newbcast:7 row_mask:0xf bank_mask:0xf
  v_and_b32_dpp v41, v77, v33 row_newbcast:7 row_mask:0xf bank_mask:0xf
  v_and_b32_dpp v42, v77, v34 row_newbcast:7 row_mask:0xf bank_mask:0xf
  v_and_b32_dpp v43, v77, v35 row_newbcast:7 row_mask:0xf bank_mask:0xf
  s_nop 1
  v_mfma_f32_16x16x32_bf16 v[24:27], v[40:43], v[140:143], v[24:27]
  s_xor_b32 s55, s51, 150528
  s_waitcnt vmcnt(4)
  buffer_load_dwordx4 v[164:167], v1, s[32:35], s55 offen nt
  v_and_b32_dpp v36, v77, v32 row_newbcast:8 row_mask:0xf bank_mask:0xf
  v_and_b32_dpp v37, v77, v33 row_newbcast:8 row_mask:0xf bank_mask:0xf
  v_and_b32_dpp v38, v77, v34 row_newbcast:8 row_mask:0xf bank_mask:0xf
  v_and_b32_dpp v39, v77, v35 row_newbcast:8 row_mask:0xf bank_mask:0xf
  s_nop 1
  v_mfma_f32_16x16x32_bf16 v[24:27], v[36:39], v[144:147], v[24:27]
  s_xor_b32 s55, s51, 164864
  s_waitcnt vmcnt(4)
  buffer_load_dwordx4 v[168:171], v1, s[32:35], s55 offen nt
  v_mfma_f32_4x4x4_16b_bf16 v[28:31], v[86:87], v[148:149], v[28:31] cbsz:4 abid:12
  v_mfma_f32_4x4x4_16b_bf16 v[72:75], v[86:87], v[150:151], v[72:75] cbsz:4 abid:12
  s_xor_b32 s55, s54, 14336
  s_waitcnt vmcnt(4)
  buffer_load_dwordx4 v[172:175], v1, s[24:27], s55 offen
  v_and_b32_dpp v40, v77, v32 row_newbcast:9 row_mask:0xf bank_mask:0xf
  v_and_b32_dpp v41, v77, v33 row_newbcast:9 row_mask:0xf bank_mask:0xf
  v_and_b32_dpp v42, v77, v34 row_newbcast:9 row_mask:0xf bank_mask:0xf
  v_and_b32_dpp v43, v77, v35 row_newbcast:9 row_mask:0xf bank_mask:0xf
  s_nop 1
  v_mfma_f32_16x16x32_bf16 v[24:27], v[40:43], v[152:155], v[24:27]
  s_xor_b32 s55, s51, 181248
  s_waitcnt vmcnt(4)
  buffer_load_dwordx4 v[176:179], v1, s[32:35], s55 offen nt
  v_and_b32_dpp v36, v77, v32 row_newbcast:10 row_mask:0xf bank_mask:0xf
  v_and_b32_dpp v37, v77, v33 row_newbcast:10 row_mask:0xf bank_mask:0xf
  v_and_b32_dpp v38, v77, v34 row_newbcast:10 row_mask:0xf bank_mask:0xf
  v_and_b32_dpp v39, v77, v35 row_newbcast:10 row_mask:0xf bank_mask:0xf
  s_nop 1
  v_mfma_f32_16x16x32_bf16 v[24:27], v[36:39], v[156:159], v[24:27]
  s_xor_b32 s55, s51, 166912
  s_waitcnt vmcnt(4)
  buffer_load_dwordx4 v[180:183], v1, s[32:35], s55 offen nt
  v_mfma_f32_4x4x4_16b_bf16 v[28:31], v[86:87], v[160:161], v[28:31] cbsz:4 abid:13
  v_mfma_f32_4x4x4_16b_bf16 v[72:75], v[86:87], v[162:163], v[72:75] cbsz:4 abid:13
  s_xor_b32 s55, s54, 15360
  s_waitcnt vmcnt(4)
  buffer_load_dwordx4 v[184:187], v1, s[24:27], s55 offen
  s_barrier
  v_and_b32_dpp v40, v77, v32 row_newbcast:11 row_mask:0xf bank_mask:0xf
  v_and_b32_dpp v41, v77, v33 row_newbcast:11 row_mask:0xf bank_mask:0xf
  v_and_b32_dpp v42, v77, v34 row_newbcast:11 row_mask:0xf bank_mask:0xf
  v_and_b32_dpp v43, v77, v35 row_newbcast:11 row_mask:0xf bank_mask:0xf
  s_nop 1
  v_mfma_f32_16x16x32_bf16 v[24:27], v[40:43], v[164:167], v[24:27]
  s_xor_b32 s55, s51, 183296
  s_waitcnt vmcnt(4)
  buffer_load_dwordx4 v[188:191], v1, s[32:35], s55 offen nt
  v_and_b32_dpp v36, v77, v32 row_newbcast:12 row_mask:0xf bank_mask:0xf
  v_and_b32_dpp v37, v77, v33 row_newbcast:12 row_mask:0xf bank_mask:0xf
  v_and_b32_dpp v38, v77, v34 row_newbcast:12 row_mask:0xf bank_mask:0xf
  v_and_b32_dpp v39, v77, v35 row_newbcast:12 row_mask:0xf bank_mask:0xf
  s_nop 1
  v_mfma_f32_16x16x32_bf16 v[24:27], v[36:39], v[168:171], v[24:27]
  s_xor_b32 s55, s51, 262144
  s_waitcnt vmcnt(4)
  buffer_load_dwordx4 v[192:195], v1, s[32:35], s55 offen nt
  v_mfma_f32_4x4x4_16b_bf16 v[28:31], v[86:87], v[172:173], v[28:31] cbsz:4 abid:14
  v_mfma_f32_4x4x4_16b_bf16 v[72:75], v[86:87], v[174:175], v[72:75] cbsz:4 abid:14
  s_waitcnt vmcnt(4)
  buffer_load_dwordx4 v[200:203], v1, s[36:39], s54 offen
  v_and_b32_dpp v40, v77, v32 row_newbcast:13 row_mask:0xf bank_mask:0xf
  v_and_b32_dpp v41, v77, v33 row_newbcast:13 row_mask:0xf bank_mask:0xf
  v_and_b32_dpp v42, v77, v34 row_newbcast:13 row_mask:0xf bank_mask:0xf
  v_and_b32_dpp v43, v77, v35 row_newbcast:13 row_mask:0xf bank_mask:0xf
  s_nop 1
  v_mfma_f32_16x16x32_bf16 v[24:27], v[40:43], v[176:179], v[24:27]
  s_xor_b32 s55, s51, 278528
  s_waitcnt vmcnt(4)
  buffer_load_dwordx4 v[204:207], v1, s[32:35], s55 offen nt
  v_and_b32_dpp v36, v77, v32 row_newbcast:14 row_mask:0xf bank_mask:0xf
  v_and_b32_dpp v37, v77, v33 row_newbcast:14 row_mask:0xf bank_mask:0xf
  v_and_b32_dpp v38, v77, v34 row_newbcast:14 row_mask:0xf bank_mask:0xf
  v_and_b32_dpp v39, v77, v35 row_newbcast:14 row_mask:0xf bank_mask:0xf
  s_nop 1
  v_mfma_f32_16x16x32_bf16 v[24:27], v[36:39], v[180:183], v[24:27]
  s_xor_b32 s55, s51, 264192
  s_waitcnt vmcnt(4)
  buffer_load_dwordx4 v[208:211], v1, s[32:35], s55 offen nt
  v_mfma_f32_4x4x4_16b_bf16 v[28:31], v[86:87], v[184:185], v[28:31] cbsz:4 abid:15
  v_mfma_f32_4x4x4_16b_bf16 v[72:75], v[86:87], v[186:187], v[72:75] cbsz:4 abid:15
  s_lshl_b32 s61, s56, 11
  s_add_u32 s61, s61, 0
  s_nop 1
  ds_write_b128 v85, v[28:31] offset:17152
  ds_write_b128 v85, v[72:75] offset:18176
  s_waitcnt lgkmcnt(0)
  s_barrier
  ds_read2st64_b32 v[44:45], v82 offset0:67 offset1:75
  ds_read2st64_b32 v[46:47], v82 offset0:83 offset1:91
  ds_read2st64_b32 v[48:49], v82 offset0:99 offset1:107
  ds_read2st64_b32 v[50:51], v82 offset0:115 offset1:123
  v_mov_b32 v10, 0
  ds_read_b128 v[60:63], v10 offset:33600
  ds_read_b128 v[64:67], v10 offset:33616
  ds_read_b128 v[68:71], v10 offset:33632
  ds_read_b128 v[72:75], v10 offset:33648
  s_xor_b32 s55, s54, 1024
  s_waitcnt vmcnt(4)
  buffer_load_dwordx4 v[212:215], v1, s[36:39], s55 offen
  s_waitcnt lgkmcnt(0)
  v_add_f32 v44, v44, v48
  v_add_f32 v45, v45, v49
  v_add_f32 v46, v46, v50
  v_add_f32 v47, v47, v51
  v_add_f32 v44, v44, v46
  v_add_f32 v45, v45, v47
  v_add_f32 v44, v44, v45
  v_add_u32 v20, 0x800, v44
  v_bfi_b32 v20, s74, v15, v20
  v_add_f32 v60, v60, v64
  v_add_f32 v61, v61, v65
  v_add_f32 v62, v62, v66
  v_add_f32 v63, v63, v67
  v_add_f32 v60, v60, v62
  v_add_f32 v61, v61, v63
  v_add_f32 v60, v60, v61
  v_add_f32 v68, v68, v72
  v_add_f32 v69, v69, v73
  v_add_f32 v70, v70, v74
  v_add_f32 v71, v71, v75
  v_add_f32 v68, v68, v70
  v_add_f32 v69, v69, v71
  v_add_f32 v68, v68, v69
  v_cmp_gt_u32 vcc, 8, v0
  s_nop 1
  v_cndmask_b32 v16, v14, v13, vcc
  v_cndmask_b32 v18, v68, v60, vcc
  v_mov_b32 v17, v15
  v_mov_b32 v19, v15
  v_and_b32_dpp v40, v77, v32 row_newbcast:15 row_mask:0xf bank_mask:0xf
  v_and_b32_dpp v41, v77, v33 row_newbcast:15 row_mask:0xf bank_mask:0xf
  v_and_b32_dpp v42, v77, v34 row_newbcast:15 row_mask:0xf bank_mask:0xf
  v_and_b32_dpp v43, v77, v35 row_newbcast:15 row_mask:0xf bank_mask:0xf
  s_nop 1
  v_mfma_f32_16x16x32_bf16 v[24:27], v[40:43], v[188:191], v[24:27]
  s_xor_b32 s55, s51, 280576
  s_waitcnt vmcnt(4)
  buffer_load_dwordx4 v[216:219], v1, s[32:35], s55 offen nt
  v_and_b32_dpp v36, v78, v32 row_newbcast:0 row_mask:0xf bank_mask:0xf
  v_and_b32_dpp v37, v78, v33 row_newbcast:0 row_mask:0xf bank_mask:0xf
  v_and_b32_dpp v38, v78, v34 row_newbcast:0 row_mask:0xf bank_mask:0xf
  v_and_b32_dpp v39, v78, v35 row_newbcast:0 row_mask:0xf bank_mask:0xf
  s_nop 1
  v_mfma_f32_16x16x32_bf16 v[24:27], v[36:39], v[192:195], v[24:27]
  s_xor_b32 s55, s51, 294912
  s_waitcnt vmcnt(4)
  buffer_load_dwordx4 v[220:223], v1, s[32:35], s55 offen nt
  s_xor_b32 s55, s54, 2048
  s_waitcnt vmcnt(4)
  buffer_load_dwordx4 v[224:227], v1, s[36:39], s55 offen
  v_and_b32_dpp v40, v78, v32 row_newbcast:1 row_mask:0xf bank_mask:0xf
  v_and_b32_dpp v41, v78, v33 row_newbcast:1 row_mask:0xf bank_mask:0xf
  v_and_b32_dpp v42, v78, v34 row_newbcast:1 row_mask:0xf bank_mask:0xf
  v_and_b32_dpp v43, v78, v35 row_newbcast:1 row_mask:0xf bank_mask:0xf
  s_nop 1
  v_mfma_f32_16x16x32_bf16 v[24:27], v[40:43], v[204:207], v[24:27]
  s_xor_b32 s55, s51, 311296
  s_waitcnt vmcnt(4)
  buffer_load_dwordx4 v[228:231], v1, s[32:35], s55 offen nt
  v_and_b32_dpp v36, v78, v32 row_newbcast:2 row_mask:0xf bank_mask:0xf
  v_and_b32_dpp v37, v78, v33 row_newbcast:2 row_mask:0xf bank_mask:0xf
  v_and_b32_dpp v38, v78, v34 row_newbcast:2 row_mask:0xf bank_mask:0xf
  v_and_b32_dpp v39, v78, v35 row_newbcast:2 row_mask:0xf bank_mask:0xf
  s_nop 1
  v_mfma_f32_16x16x32_bf16 v[24:27], v[36:39], v[208:211], v[24:27]
  s_xor_b32 s55, s51, 296960
  s_waitcnt vmcnt(4)
  buffer_load_dwordx4 v[232:235], v1, s[32:35], s55 offen nt
  s_barrier
  s_xor_b32 s55, s54, 3072
  s_waitcnt vmcnt(4)
  buffer_load_dwordx4 v[236:239], v1, s[36:39], s55 offen
  v_and_b32_dpp v40, v78, v32 row_newbcast:3 row_mask:0xf bank_mask:0xf
  v_and_b32_dpp v41, v78, v33 row_newbcast:3 row_mask:0xf bank_mask:0xf
  v_and_b32_dpp v42, v78, v34 row_newbcast:3 row_mask:0xf bank_mask:0xf
  v_and_b32_dpp v43, v78, v35 row_newbcast:3 row_mask:0xf bank_mask:0xf
  s_nop 1
  v_mfma_f32_16x16x32_bf16 v[24:27], v[40:43], v[216:219], v[24:27]
  s_xor_b32 s55, s51, 313344
  s_waitcnt vmcnt(4)
  buffer_load_dwordx4 v[240:243], v1, s[32:35], s55 offen nt
  v_and_b32_dpp v36, v78, v32 row_newbcast:4 row_mask:0xf bank_mask:0xf
  v_and_b32_dpp v37, v78, v33 row_newbcast:4 row_mask:0xf bank_mask:0xf
  v_and_b32_dpp v38, v78, v34 row_newbcast:4 row_mask:0xf bank_mask:0xf
  v_and_b32_dpp v39, v78, v35 row_newbcast:4 row_mask:0xf bank_mask:0xf
  s_nop 1
  v_mfma_f32_16x16x32_bf16 v[24:27], v[36:39], v[220:223], v[24:27]
  s_xor_b32 s55, s51, 263168
  s_waitcnt vmcnt(4)
  buffer_load_dwordx4 v[244:247], v1, s[32:35], s55 offen nt
  s_xor_b32 s55, s54, 4096
  s_waitcnt vmcnt(4)
  buffer_load_dwordx4 v[248:251], v1, s[36:39], s55 offen
  v_and_b32_dpp v40, v78, v32 row_newbcast:5 row_mask:0xf bank_mask:0xf
  v_and_b32_dpp v41, v78, v33 row_newbcast:5 row_mask:0xf bank_mask:0xf
  v_and_b32_dpp v42, v78, v34 row_newbcast:5 row_mask:0xf bank_mask:0xf
  v_and_b32_dpp v43, v78, v35 row_newbcast:5 row_mask:0xf bank_mask:0xf
  s_nop 1
  v_mfma_f32_16x16x32_bf16 v[24:27], v[40:43], v[228:231], v[24:27]
  s_xor_b32 s55, s51, 279552
  s_waitcnt vmcnt(4)
  buffer_load_dwordx4 v[252:255], v1, s[32:35], s55 offen nt
  v_and_b32_dpp v36, v78, v32 row_newbcast:6 row_mask:0xf bank_mask:0xf
  v_and_b32_dpp v37, v78, v33 row_newbcast:6 row_mask:0xf bank_mask:0xf
  v_and_b32_dpp v38, v78, v34 row_newbcast:6 row_mask:0xf bank_mask:0xf
  v_and_b32_dpp v39, v78, v35 row_newbcast:6 row_mask:0xf bank_mask:0xf
  s_nop 1
  v_mfma_f32_16x16x32_bf16 v[24:27], v[36:39], v[232:235], v[24:27]
  s_xor_b32 s55, s51, 265216
  s_waitcnt vmcnt(4)
  buffer_load_dwordx4 v[92:95], v1, s[32:35], s55 offen nt
  s_barrier
  s_xor_b32 s55, s54, 5120
  s_waitcnt vmcnt(4)
  buffer_load_dwordx4 v[96:99], v1, s[36:39], s55 offen
  v_and_b32_dpp v40, v78, v32 row_newbcast:7 row_mask:0xf bank_mask:0xf
  v_and_b32_dpp v41, v78, v33 row_newbcast:7 row_mask:0xf bank_mask:0xf
  v_and_b32_dpp v42, v78, v34 row_newbcast:7 row_mask:0xf bank_mask:0xf
  v_and_b32_dpp v43, v78, v35 row_newbcast:7 row_mask:0xf bank_mask:0xf
  s_nop 1
  v_mfma_f32_16x16x32_bf16 v[24:27], v[40:43], v[240:243], v[24:27]
  s_xor_b32 s55, s51, 281600
  s_waitcnt vmcnt(4)
  buffer_load_dwordx4 v[100:103], v1, s[32:35], s55 offen nt
  v_and_b32_dpp v36, v78, v32 row_newbcast:8 row_mask:0xf bank_mask:0xf
  v_and_b32_dpp v37, v78, v33 row_newbcast:8 row_mask:0xf bank_mask:0xf
  v_and_b32_dpp v38, v78, v34 row_newbcast:8 row_mask:0xf bank_mask:0xf
  v_and_b32_dpp v39, v78, v35 row_newbcast:8 row_mask:0xf bank_mask:0xf
  s_nop 1
  v_mfma_f32_16x16x32_bf16 v[24:27], v[36:39], v[244:247], v[24:27]
  s_xor_b32 s55, s51, 295936
  s_waitcnt vmcnt(4)
  buffer_load_dwordx4 v[104:107], v1, s[32:35], s55 offen nt
  s_xor_b32 s55, s54, 6144
  s_waitcnt vmcnt(4)
  buffer_load_dwordx4 v[196:199], v1, s[36:39], s55 offen
  v_and_b32_dpp v40, v78, v32 row_newbcast:9 row_mask:0xf bank_mask:0xf
  v_and_b32_dpp v41, v78, v33 row_newbcast:9 row_mask:0xf bank_mask:0xf
  v_and_b32_dpp v42, v78, v34 row_newbcast:9 row_mask:0xf bank_mask:0xf
  v_and_b32_dpp v43, v78, v35 row_newbcast:9 row_mask:0xf bank_mask:0xf
  s_nop 1
  v_mfma_f32_16x16x32_bf16 v[24:27], v[40:43], v[252:255], v[24:27]
  s_xor_b32 s55, s51, 312320
  s_waitcnt vmcnt(4)
  buffer_load_dwordx4 v[108:111], v1, s[32:35], s55 offen nt
  v_and_b32_dpp v36, v78, v32 row_newbcast:10 row_mask:0xf bank_mask:0xf
  v_and_b32_dpp v37, v78, v33 row_newbcast:10 row_mask:0xf bank_mask:0xf
  v_and_b32_dpp v38, v78, v34 row_newbcast:10 row_mask:0xf bank_mask:0xf
  v_and_b32_dpp v39, v78, v35 row_newbcast:10 row_mask:0xf bank_mask:0xf
  s_nop 1
  v_mfma_f32_16x16x32_bf16 v[24:27], v[36:39], v[92:95], v[24:27]
  s_xor_b32 s55, s51, 297984
  s_waitcnt vmcnt(4)
  buffer_load_dwordx4 v[112:115], v1, s[32:35], s55 offen nt
  s_barrier
  s_xor_b32 s55, s54, 7168
  s_waitcnt vmcnt(4)
  buffer_load_dwordx4 v[116:119], v1, s[36:39], s55 offen
  v_and_b32_dpp v40, v78, v32 row_newbcast:11 row_mask:0xf bank_mask:0xf
  v_and_b32_dpp v41, v78, v33 row_newbcast:11 row_mask:0xf bank_mask:0xf
  v_and_b32_dpp v42, v78, v34 row_newbcast:11 row_mask:0xf bank_mask:0xf
  v_and_b32_dpp v43, v78, v35 row_newbcast:11 row_mask:0xf bank_mask:0xf
  s_nop 1
  v_mfma_f32_16x16x32_bf16 v[24:27], v[40:43], v[100:103], v[24:27]
  s_xor_b32 s55, s51, 314368
  s_waitcnt vmcnt(4)
  buffer_load_dwordx4 v[120:123], v1, s[32:35], s55 offen nt
  v_and_b32_dpp v36, v78, v32 row_newbcast:12 row_mask:0xf bank_mask:0xf
  v_and_b32_dpp v37, v78, v33 row_newbcast:12 row_mask:0xf bank_mask:0xf
  v_and_b32_dpp v38, v78, v34 row_newbcast:12 row_mask:0xf bank_mask:0xf
  v_and_b32_dpp v39, v78, v35 row_newbcast:12 row_mask:0xf bank_mask:0xf
  s_nop 1
  v_mfma_f32_16x16x32_bf16 v[24:27], v[36:39], v[104:107], v[24:27]
  s_xor_b32 s55, s51, 393216
  s_waitcnt vmcnt(4)
  buffer_load_dwordx4 v[124:127], v1, s[32:35], s55 offen nt
  s_xor_b32 s55, s54, 8192
  s_waitcnt vmcnt(4)
  buffer_load_dwordx4 v[128:131], v1, s[36:39], s55 offen
  v_and_b32_dpp v40, v78, v32 row_newbcast:13 row_mask:0xf bank_mask:0xf
  v_and_b32_dpp v41, v78, v33 row_newbcast:13 row_mask:0xf bank_mask:0xf
  v_and_b32_dpp v42, v78, v34 row_newbcast:13 row_mask:0xf bank_mask:0xf
  v_and_b32_dpp v43, v78, v35 row_newbcast:13 row_mask:0xf bank_mask:0xf
  s_nop 1
  v_mfma_f32_16x16x32_bf16 v[24:27], v[40:43], v[108:111], v[24:27]
  s_xor_b32 s55, s51, 409600
  s_waitcnt vmcnt(4)
  buffer_load_dwordx4 v[132:135], v1, s[32:35], s55 offen nt
  v_and_b32_dpp v36, v78, v32 row_newbcast:14 row_mask:0xf bank_mask:0xf
  v_and_b32_dpp v37, v78, v33 row_newbcast:14 row_mask:0xf bank_mask:0xf
  v_and_b32_dpp v38, v78, v34 row_newbcast:14 row_mask:0xf bank_mask:0xf
  v_and_b32_dpp v39, v78, v35 row_newbcast:14 row_mask:0xf bank_mask:0xf
  s_nop 1
  v_mfma_f32_16x16x32_bf16 v[24:27], v[36:39], v[112:115], v[24:27]
  s_xor_b32 s55, s51, 395264
  s_waitcnt vmcnt(4)
  buffer_load_dwordx4 v[136:139], v1, s[32:35], s55 offen nt
  s_barrier
  s_xor_b32 s55, s54, 9216
  s_waitcnt vmcnt(4)
  buffer_load_dwordx4 v[140:143], v1, s[36:39], s55 offen
  v_and_b32_dpp v40, v78, v32 row_newbcast:15 row_mask:0xf bank_mask:0xf
  v_and_b32_dpp v41, v78, v33 row_newbcast:15 row_mask:0xf bank_mask:0xf
  v_and_b32_dpp v42, v78, v34 row_newbcast:15 row_mask:0xf bank_mask:0xf
  v_and_b32_dpp v43, v78, v35 row_newbcast:15 row_mask:0xf bank_mask:0xf
  s_nop 1
  v_mfma_f32_16x16x32_bf16 v[24:27], v[40:43], v[120:123], v[24:27]
  s_xor_b32 s55, s51, 411648
  s_waitcnt vmcnt(4)
  buffer_load_dwordx4 v[144:147], v1, s[32:35], s55 offen nt
  v_and_b32_dpp v36, v79, v32 row_newbcast:0 row_mask:0xf bank_mask:0xf
  v_and_b32_dpp v37, v79, v33 row_newbcast:0 row_mask:0xf bank_mask:0xf
  v_and_b32_dpp v38, v79, v34 row_newbcast:0 row_mask:0xf bank_mask:0xf
  v_and_b32_dpp v39, v79, v35 row_newbcast:0 row_mask:0xf bank_mask:0xf
  s_nop 1
  v_mfma_f32_16x16x32_bf16 v[24:27], v[36:39], v[124:127], v[24:27]
  s_xor_b32 s55, s51, 425984
  s_waitcnt vmcnt(4)
  buffer_load_dwordx4 v[148:151], v1, s[32:35], s55 offen nt
  s_xor_b32 s55, s54, 10240
  s_waitcnt vmcnt(4)
  buffer_load_dwordx4 v[152:155], v1, s[36:39], s55 offen
  v_and_b32_dpp v40, v79, v32 row_newbcast:1 row_mask:0xf bank_mask:0xf
  v_and_b32_dpp v41, v79, v33 row_newbcast:1 row_mask:0xf bank_mask:0xf
  v_and_b32_dpp v42, v79, v34 row_newbcast:1 row_mask:0xf bank_mask:0xf
  v_and_b32_dpp v43, v79, v35 row_newbcast:1 row_mask:0xf bank_mask:0xf
  s_nop 1
  v_mfma_f32_16x16x32_bf16 v[24:27], v[40:43], v[132:135], v[24:27]
  s_xor_b32 s55, s51, 442368
  s_waitcnt vmcnt(4)
  buffer_load_dwordx4 v[156:159], v1, s[32:35], s55 offen nt
  v_and_b32_dpp v36, v79, v32 row_newbcast:2 row_mask:0xf bank_mask:0xf
  v_and_b32_dpp v37, v79, v33 row_newbcast:2 row_mask:0xf bank_mask:0xf
  v_and_b32_dpp v38, v79, v34 row_newbcast:2 row_mask:0xf bank_mask:0xf
  v_and_b32_dpp v39, v79, v35 row_newbcast:2 row_mask:0xf bank_mask:0xf
  s_nop 1
  v_mfma_f32_16x16x32_bf16 v[24:27], v[36:39], v[136:139], v[24:27]
  s_xor_b32 s55, s51, 428032
  s_waitcnt vmcnt(4)
  buffer_load_dwordx4 v[160:163], v1, s[32:35], s55 offen nt
  s_barrier
  s_xor_b32 s55, s54, 11264
  s_waitcnt vmcnt(4)
  buffer_load_dwordx4 v[164:167], v1, s[36:39], s55 offen
  v_and_b32_dpp v40, v79, v32 row_newbcast:3 row_mask:0xf bank_mask:0xf
  v_and_b32_dpp v41, v79, v33 row_newbcast:3 row_mask:0xf bank_mask:0xf
  v_and_b32_dpp v42, v79, v34 row_newbcast:3 row_mask:0xf bank_mask:0xf
  v_and_b32_dpp v43, v79, v35 row_newbcast:3 row_mask:0xf bank_mask:0xf
  s_nop 1
  v_mfma_f32_16x16x32_bf16 v[24:27], v[40:43], v[144:147], v[24:27]
  s_xor_b32 s55, s51, 444416
  s_waitcnt vmcnt(4)
  buffer_load_dwordx4 v[168:171], v1, s[32:35], s55 offen nt
  s_mov_b32 s75, s2
  v_lshrrev_b32 v5, 3, v0
  s_lshl_b32 s7, s3, 4
  v_add_u32 v5, s7, v5
  v_and_b32 v6, 7, v0
  v_lshlrev_b32 v6, 4, v6
  v_lshl_add_u32 v69, v5, 11, v6
  v_lshlrev_b32 v68, 7, v5
  s_lshr_b32 s7, s75, 4
  s_lshl_b32 s53, s7, 18
  s_and_b32 s50, s75, 15
  s_lshl_b32 s50, s50, 7
  s_add_u32 s53, s53, s50
  s_lshl_b32 s52, s7, 14
  s_add_u32 s52, s52, 1048576
  s_cmp_lt_u32 s75, 64
  s_cselect_b32 s52, s52, 1073741824
  s_cselect_b32 s53, s53, 1073741824
  s_add_u32 s76, s53, 16384
  v_and_b32_dpp v36, v79, v32 row_newbcast:4 row_mask:0xf bank_mask:0xf
  v_and_b32_dpp v37, v79, v33 row_newbcast:4 row_mask:0xf bank_mask:0xf
  v_and_b32_dpp v38, v79, v34 row_newbcast:4 row_mask:0xf bank_mask:0xf
  v_and_b32_dpp v39, v79, v35 row_newbcast:4 row_mask:0xf bank_mask:0xf
  s_nop 1
  v_mfma_f32_16x16x32_bf16 v[24:27], v[36:39], v[148:151], v[24:27]
  s_xor_b32 s55, s51, 394240
  s_waitcnt vmcnt(4)
  buffer_load_dwordx4 v[172:175], v1, s[32:35], s55 offen nt
  s_xor_b32 s55, s54, 12288
  s_waitcnt vmcnt(4)
  buffer_load_dwordx4 v[176:179], v1, s[36:39], s55 offen
  v_and_b32_dpp v40, v79, v32 row_newbcast:5 row_mask:0xf bank_mask:0xf
  v_and_b32_dpp v41, v79, v33 row_newbcast:5 row_mask:0xf bank_mask:0xf
  v_and_b32_dpp v42, v79, v34 row_newbcast:5 row_mask:0xf bank_mask:0xf
  v_and_b32_dpp v43, v79, v35 row_newbcast:5 row_mask:0xf bank_mask:0xf
  s_nop 1
  v_mfma_f32_16x16x32_bf16 v[24:27], v[40:43], v[156:159], v[24:27]
  s_xor_b32 s55, s51, 410624
  s_waitcnt vmcnt(4)
  buffer_load_dwordx4 v[180:183], v1, s[32:35], s55 offen nt
  v_and_b32_dpp v36, v79, v32 row_newbcast:6 row_mask:0xf bank_mask:0xf
  v_and_b32_dpp v37, v79, v33 row_newbcast:6 row_mask:0xf bank_mask:0xf
  v_and_b32_dpp v38, v79, v34 row_newbcast:6 row_mask:0xf bank_mask:0xf
  v_and_b32_dpp v39, v79, v35 row_newbcast:6 row_mask:0xf bank_mask:0xf
  s_nop 1
  v_mfma_f32_16x16x32_bf16 v[24:27], v[36:39], v[160:163], v[24:27]
  s_xor_b32 s55, s51, 396288
  s_waitcnt vmcnt(4)
  buffer_load_dwordx4 v[184:187], v1, s[32:35], s55 offen nt
  s_barrier
  s_xor_b32 s55, s54, 13312
  s_waitcnt vmcnt(4)
  buffer_load_dwordx4 v[188:191], v1, s[36:39], s55 offen
  v_and_b32_dpp v40, v79, v32 row_newbcast:7 row_mask:0xf bank_mask:0xf
  v_and_b32_dpp v41, v79, v33 row_newbcast:7 row_mask:0xf bank_mask:0xf
  v_and_b32_dpp v42, v79, v34 row_newbcast:7 row_mask:0xf bank_mask:0xf
  v_and_b32_dpp v43, v79, v35 row_newbcast:7 row_mask:0xf bank_mask:0xf
  s_nop 1
  v_mfma_f32_16x16x32_bf16 v[24:27], v[40:43], v[168:171], v[24:27]
  s_xor_b32 s55, s51, 412672
  s_waitcnt vmcnt(4)
  buffer_load_dwordx4 v[192:195], v1, s[32:35], s55 offen nt
  v_and_b32_dpp v36, v79, v32 row_newbcast:8 row_mask:0xf bank_mask:0xf
  v_and_b32_dpp v37, v79, v33 row_newbcast:8 row_mask:0xf bank_mask:0xf
  v_and_b32_dpp v38, v79, v34 row_newbcast:8 row_mask:0xf bank_mask:0xf
  v_and_b32_dpp v39, v79, v35 row_newbcast:8 row_mask:0xf bank_mask:0xf
  s_nop 1
  v_mfma_f32_16x16x32_bf16 v[24:27], v[36:39], v[172:175], v[24:27]
  s_xor_b32 s55, s51, 427008
  s_waitcnt vmcnt(4)
  buffer_load_dwordx4 v[204:207], v1, s[32:35], s55 offen nt
  s_xor_b32 s55, s54, 14336
  s_waitcnt vmcnt(4)
  buffer_load_dwordx4 v[208:211], v1, s[36:39], s55 offen
  v_and_b32_dpp v40, v79, v32 row_newbcast:9 row_mask:0xf bank_mask:0xf
  v_and_b32_dpp v41, v79, v33 row_newbcast:9 row_mask:0xf bank_mask:0xf
  v_and_b32_dpp v42, v79, v34 row_newbcast:9 row_mask:0xf bank_mask:0xf
  v_and_b32_dpp v43, v79, v35 row_newbcast:9 row_mask:0xf bank_mask:0xf
  s_nop 1
  v_mfma_f32_16x16x32_bf16 v[24:27], v[40:43], v[180:183], v[24:27]
  s_xor_b32 s55, s51, 443392
  s_waitcnt vmcnt(4)
  buffer_load_dwordx4 v[216:219], v1, s[32:35], s55 offen nt
  v_and_b32_dpp v36, v79, v32 row_newbcast:10 row_mask:0xf bank_mask:0xf
  v_and_b32_dpp v37, v79, v33 row_newbcast:10 row_mask:0xf bank_mask:0xf
  v_and_b32_dpp v38, v79, v34 row_newbcast:10 row_mask:0xf bank_mask:0xf
  v_and_b32_dpp v39, v79, v35 row_newbcast:10 row_mask:0xf bank_mask:0xf
  s_nop 1
  v_mfma_f32_16x16x32_bf16 v[24:27], v[36:39], v[184:187], v[24:27]
  s_xor_b32 s55, s51, 429056
  s_waitcnt vmcnt(4)
  buffer_load_dwordx4 v[220:223], v1, s[32:35], s55 offen nt
  s_xor_b32 s55, s54, 15360
  s_waitcnt vmcnt(4)
  buffer_load_dwordx4 v[228:231], v1, s[36:39], s55 offen
  v_and_b32_dpp v40, v79, v32 row_newbcast:11 row_mask:0xf bank_mask:0xf
  v_and_b32_dpp v41, v79, v33 row_newbcast:11 row_mask:0xf bank_mask:0xf
  v_and_b32_dpp v42, v79, v34 row_newbcast:11 row_mask:0xf bank_mask:0xf
  v_and_b32_dpp v43, v79, v35 row_newbcast:11 row_mask:0xf bank_mask:0xf
  s_nop 1
  v_mfma_f32_16x16x32_bf16 v[24:27], v[40:43], v[192:195], v[24:27]
  s_xor_b32 s55, s51, 445440
  s_waitcnt vmcnt(4)
  buffer_load_dwordx4 v[232:235], v1, s[32:35], s55 offen nt
  s_lshl_b32 s7, s56, 7
  s_add_u32 s7, s7, 1048576
  s_cmp_eq_u32 s3, 0
  s_cselect_b32 s7, s7, 1073741824
  v_lshrrev_b32 v5, 3, v0
  v_lshlrev_b32 v5, 15, v5
  v_and_b32 v6, 7, v0
  v_lshl_add_u32 v5, v6, 4, v5
  v_mov_b32 v6, 1073741824
  v_cmp_gt_u32 vcc, 16, v0
  s_nop 1
  v_cndmask_b32 v5, v6, v5, vcc
  buffer_store_dwordx4 v[16:19], v5, s[44:47], s7 offen sc1
  buffer_store_dword v20, v82, s[44:47], s61 offen sc1
  v_and_b32_dpp v36, v79, v32 row_newbcast:12 row_mask:0xf bank_mask:0xf
  v_and_b32_dpp v37, v79, v33 row_newbcast:12 row_mask:0xf bank_mask:0xf
  v_and_b32_dpp v38, v79, v34 row_newbcast:12 row_mask:0xf bank_mask:0xf
  v_and_b32_dpp v39, v79, v35 row_newbcast:12 row_mask:0xf bank_mask:0xf
  s_nop 1
  v_mfma_f32_16x16x32_bf16 v[24:27], v[36:39], v[204:207], v[24:27]
  v_and_b32_dpp v40, v79, v32 row_newbcast:13 row_mask:0xf bank_mask:0xf
  v_and_b32_dpp v41, v79, v33 row_newbcast:13 row_mask:0xf bank_mask:0xf
  v_and_b32_dpp v42, v79, v34 row_newbcast:13 row_mask:0xf bank_mask:0xf
  v_and_b32_dpp v43, v79, v35 row_newbcast:13 row_mask:0xf bank_mask:0xf
  s_waitcnt vmcnt(5)
  s_nop 0
  v_mfma_f32_16x16x32_bf16 v[24:27], v[40:43], v[216:219], v[24:27]
  v_and_b32_dpp v36, v79, v32 row_newbcast:14 row_mask:0xf bank_mask:0xf
  v_and_b32_dpp v37, v79, v33 row_newbcast:14 row_mask:0xf bank_mask:0xf
  v_and_b32_dpp v38, v79, v34 row_newbcast:14 row_mask:0xf bank_mask:0xf
  v_and_b32_dpp v39, v79, v35 row_newbcast:14 row_mask:0xf bank_mask:0xf
  s_waitcnt vmcnt(4)
  s_nop 0
  v_mfma_f32_16x16x32_bf16 v[24:27], v[36:39], v[220:223], v[24:27]
  s_waitcnt vmcnt(2)
  v_and_b32_dpp v40, v79, v32 row_newbcast:15 row_mask:0xf bank_mask:0xf
  v_and_b32_dpp v41, v79, v33 row_newbcast:15 row_mask:0xf bank_mask:0xf
  v_and_b32_dpp v42, v79, v34 row_newbcast:15 row_mask:0xf bank_mask:0xf
  v_and_b32_dpp v43, v79, v35 row_newbcast:15 row_mask:0xf bank_mask:0xf
  s_nop 1
  v_mfma_f32_16x16x32_bf16 v[24:27], v[40:43], v[232:235], v[24:27]
  s_mov_b64 exec, 0xffffffff
  s_nop 6
  ds_write_b128 v3, v[24:27] offset:12288
  s_mov_b64 exec, -1
  s_waitcnt lgkmcnt(0)
  s_barrier
  ds_read2_b32 v[44:45], v4 offset0:0 offset1:132
  buffer_load_dwordx4 v[60:63], v68, s[44:47], s52 offen offset:0 sc1
  buffer_load_dwordx4 v[64:67], v68, s[44:47], s52 offen offset:1024 sc1
  buffer_load_dwordx4 v[232:235], v69, s[44:47], s53 offen sc1
  buffer_load_dwordx4 v[220:223], v69, s[44:47], s76 offen sc1
  s_waitcnt lgkmcnt(0)
  v_add_f32 v44, v44, v45
  s_nop 1
  v_add_f32_dpp v44, v44, v44 quad_perm:[1,0,3,2] row_mask:0xf bank_mask:0xf
  s_nop 1
  v_add_f32_dpp v44, v44, v44 quad_perm:[2,3,0,1] row_mask:0xf bank_mask:0xf
  v_cvt_pk_bf16_f32 v81, v44, v44
  v_and_b32 v86, v81, v88
  v_and_b32 v87, v81, v89
  s_nop 1
  v_mfma_f32_4x4x4_16b_bf16 v[28:31], v[86:87], v[200:201], 0 cbsz:4 abid:0
  v_mfma_f32_4x4x4_16b_bf16 v[72:75], v[86:87], v[202:203], 0 cbsz:4 abid:0
  s_nop 0
  v_mfma_f32_4x4x4_16b_bf16 v[28:31], v[86:87], v[212:213], v[28:31] cbsz:4 abid:1
  v_mfma_f32_4x4x4_16b_bf16 v[72:75], v[86:87], v[214:215], v[72:75] cbsz:4 abid:1
  s_nop 0
  v_mfma_f32_4x4x4_16b_bf16 v[28:31], v[86:87], v[224:225], v[28:31] cbsz:4 abid:2
  v_mfma_f32_4x4x4_16b_bf16 v[72:75], v[86:87], v[226:227], v[72:75] cbsz:4 abid:2
  s_nop 0
  v_mfma_f32_4x4x4_16b_bf16 v[28:31], v[86:87], v[236:237], v[28:31] cbsz:4 abid:3
  v_mfma_f32_4x4x4_16b_bf16 v[72:75], v[86:87], v[238:239], v[72:75] cbsz:4 abid:3
  s_nop 0
  v_mfma_f32_4x4x4_16b_bf16 v[28:31], v[86:87], v[248:249], v[28:31] cbsz:4 abid:4
  v_mfma_f32_4x4x4_16b_bf16 v[72:75], v[86:87], v[250:251], v[72:75] cbsz:4 abid:4
  s_nop 0
  v_mfma_f32_4x4x4_16b_bf16 v[28:31], v[86:87], v[96:97], v[28:31] cbsz:4 abid:5
  v_mfma_f32_4x4x4_16b_bf16 v[72:75], v[86:87], v[98:99], v[72:75] cbsz:4 abid:5
  s_nop 0
  v_mfma_f32_4x4x4_16b_bf16 v[28:31], v[86:87], v[196:197], v[28:31] cbsz:4 abid:6
  v_mfma_f32_4x4x4_16b_bf16 v[72:75], v[86:87], v[198:199], v[72:75] cbsz:4 abid:6
  s_nop 0
  v_mfma_f32_4x4x4_16b_bf16 v[28:31], v[86:87], v[116:117], v[28:31] cbsz:4 abid:7
  v_mfma_f32_4x4x4_16b_bf16 v[72:75], v[86:87], v[118:119], v[72:75] cbsz:4 abid:7
  s_nop 0
  v_mfma_f32_4x4x4_16b_bf16 v[28:31], v[86:87], v[128:129], v[28:31] cbsz:4 abid:8
  v_mfma_f32_4x4x4_16b_bf16 v[72:75], v[86:87], v[130:131], v[72:75] cbsz:4 abid:8
  s_nop 0
  v_mfma_f32_4x4x4_16b_bf16 v[28:31], v[86:87], v[140:141], v[28:31] cbsz:4 abid:9
  v_mfma_f32_4x4x4_16b_bf16 v[72:75], v[86:87], v[142:143], v[72:75] cbsz:4 abid:9
  s_nop 0
  v_mfma_f32_4x4x4_16b_bf16 v[28:31], v[86:87], v[152:153], v[28:31] cbsz:4 abid:10
  v_mfma_f32_4x4x4_16b_bf16 v[72:75], v[86:87], v[154:155], v[72:75] cbsz:4 abid:10
  s_nop 0
  v_mfma_f32_4x4x4_16b_bf16 v[28:31], v[86:87], v[164:165], v[28:31] cbsz:4 abid:11
  v_mfma_f32_4x4x4_16b_bf16 v[72:75], v[86:87], v[166:167], v[72:75] cbsz:4 abid:11
  s_nop 0
  v_mfma_f32_4x4x4_16b_bf16 v[28:31], v[86:87], v[176:177], v[28:31] cbsz:4 abid:12
  v_mfma_f32_4x4x4_16b_bf16 v[72:75], v[86:87], v[178:179], v[72:75] cbsz:4 abid:12
  s_nop 0
  v_mfma_f32_4x4x4_16b_bf16 v[28:31], v[86:87], v[188:189], v[28:31] cbsz:4 abid:13
  v_mfma_f32_4x4x4_16b_bf16 v[72:75], v[86:87], v[190:191], v[72:75] cbsz:4 abid:13
  s_nop 0
  v_mfma_f32_4x4x4_16b_bf16 v[28:31], v[86:87], v[208:209], v[28:31] cbsz:4 abid:14
  v_mfma_f32_4x4x4_16b_bf16 v[72:75], v[86:87], v[210:211], v[72:75] cbsz:4 abid:14
  s_nop 0
  v_mfma_f32_4x4x4_16b_bf16 v[28:31], v[86:87], v[228:229], v[28:31] cbsz:4 abid:15
  v_mfma_f32_4x4x4_16b_bf16 v[72:75], v[86:87], v[230:231], v[72:75] cbsz:4 abid:15
  s_lshl_b32 s61, s56, 11
  s_add_u32 s61, s61, 524288
  s_nop 1
  ds_write_b128 v85, v[28:31] offset:17152
  ds_write_b128 v85, v[72:75] offset:18176
  s_waitcnt lgkmcnt(0)
  s_barrier
  ds_read2st64_b32 v[44:45], v82 offset0:67 offset1:75
  ds_read2st64_b32 v[46:47], v82 offset0:83 offset1:91
  ds_read2st64_b32 v[48:49], v82 offset0:99 offset1:107
  ds_read2st64_b32 v[50:51], v82 offset0:115 offset1:123
  s_waitcnt lgkmcnt(0)
  v_add_f32 v44, v44, v48
  v_add_f32 v45, v45, v49
  v_add_f32 v46, v46, v50
  v_add_f32 v47, v47, v51
  v_add_f32 v44, v44, v46
  v_add_f32 v45, v45, v47
  v_add_f32 v44, v44, v45
  v_add_u32 v24, 0x800, v44
  v_bfi_b32 v24, s74, v15, v24
  buffer_store_dword v24, v82, s[44:47], s61 offen sc1
  s_cmp_ge_u32 s75, 64
  s_cbranch_scc1 L_fin
  s_mov_b32 s60, 0
  s_mov_b64 s[68:69], -1
  s_not_b32 s54, s74
  v_and_b32 v21, s74, v15
  s_waitcnt vmcnt(1)
  v_or3_b32 v7, v232, v233, v234
  v_or3_b32 v7, v7, v235, v220
  v_or3_b32 v7, v7, v221, v222
  v_bitop3_b32 v8, v232, v233, v234 bitop3:0x80
  v_bitop3_b32 v8, v8, v235, v220 bitop3:0x80
  v_bitop3_b32 v8, v8, v221, v222 bitop3:0x80
  v_or_b32 v7, v7, v223
  v_and_b32 v8, v8, v223
  v_and_b32 v7, s74, v7
  v_and_b32 v8, s74, v8
  v_cmp_eq_u32 vcc, v7, v21
  v_cmp_eq_u32 s[70:71], v8, v21
  s_nop 0
  s_and_b64 vcc, vcc, s[70:71]
  s_and_b64 exec, vcc, s[68:69]
  v_and_b32 v44, s54, v232
  v_and_b32 v45, s54, v233
  v_and_b32 v46, s54, v234
  v_and_b32 v47, s54, v235
  v_and_b32 v48, s54, v220
  v_and_b32 v49, s54, v221
  v_and_b32 v50, s54, v222
  v_and_b32 v51, s54, v223
  s_andn2_b64 s[68:69], s[68:69], vcc
  s_cbranch_scc0 L_nopoll0
  s_mov_b64 exec, s[68:69]
  buffer_load_dwordx4 v[232:235], v69, s[44:47], s53 offen sc1
  buffer_load_dwordx4 v[220:223], v69, s[44:47], s76 offen sc1
L_nopoll0:
  s_mov_b64 exec, -1
  v_xor_b32 v7, v61, v15
  v_xor_b32 v8, v63, v15
  v_xor_b32 v9, v65, v15
  v_xor_b32 v10, v67, v15
  v_or3_b32 v7, v7, v8, v9
  v_or_b32 v7, v7, v10
  v_cmp_ne_u32 vcc, 0, v7
  s_nop 0
  s_cmp_lg_u64 vcc, 0
  s_cbranch_scc0 L_mlok
L_mlchk:
  buffer_load_dwordx4 v[60:63], v68, s[44:47], s52 offen offset:0 sc1
  buffer_load_dwordx4 v[64:67], v68, s[44:47], s52 offen offset:1024 sc1
  s_add_u32 s60, s60, 1
  s_waitcnt vmcnt(0)
  s_cmp_ge_u32 s60, 0x20000
  s_cbranch_scc1 L_mlok
  v_xor_b32 v7, v61, v15
  v_xor_b32 v8, v63, v15
  v_xor_b32 v9, v65, v15
  v_xor_b32 v10, v67, v15
  v_or3_b32 v7, v7, v8, v9
  v_or_b32 v7, v7, v10
  v_cmp_ne_u32 vcc, 0, v7
  s_nop 0
  s_cmp_lg_u64 vcc, 0
  s_cbranch_scc1 L_mlchk
L_mlok:
  v_max_f32_dpp v7, v60, v60 row_ror:8 row_mask:0xf bank_mask:0xf
  v_max_f32_dpp v8, v64, v64 row_ror:8 row_mask:0xf bank_mask:0xf
  v_mov_b32 v9, v7
  v_mov_b32 v10, v8
  s_nop 0
  v_permlane16_swap_b32 v7, v9
  v_permlane16_swap_b32 v8, v10
  v_max_f32 v7, v7, v9
  v_max_f32 v8, v8, v10
  v_sub_f32 v7, v60, v7
  v_sub_f32 v8, v64, v8
  v_mul_f32 v7, s59, v7
  v_mul_f32 v8, s59, v8
  v_exp_f32 v18, v7
  v_exp_f32 v19, v8
  v_mul_f32 v7, v18, v62
  v_mul_f32 v8, v19, v66
  s_nop 0
  v_add_f32_dpp v7, v7, v7 row_ror:8 row_mask:0xf bank_mask:0xf
  v_add_f32_dpp v8, v8, v8 row_ror:8 row_mask:0xf bank_mask:0xf
  v_mov_b32 v9, v7
  v_mov_b32 v10, v8
  s_nop 0
  v_permlane16_swap_b32 v7, v9
  v_permlane16_swap_b32 v8, v10
  v_add_f32 v7, v7, v9
  v_add_f32 v8, v8, v10
  v_rcp_f32 v7, v7
  v_rcp_f32 v8, v8
  v_mul_f32 v18, v18, v7
  v_mul_f32 v19, v19, v8
  v_and_b32 v11, 7, v0
  v_lshlrev_b32 v11, 2, v11
  v_bfe_u32 v7, v0, 3, 1
  v_lshl_add_u32 v11, v7, 1, v11
  v_bfe_u32 v7, v0, 4, 1
  v_add_u32 v11, v7, v11
  v_lshlrev_b32 v11, 2, v11
  s_lshl_b32 s50, s3, 7
  v_add_u32 v11, s50, v11
  v_and_b32 v16, 15, v0
  v_lshlrev_b32 v17, 3, v16
  v_and_b32 v7, 1, v0
  v_lshlrev_b32 v7, 2, v7
  v_lshrrev_b32 v16, 1, v16
  v_lshl_add_u32 v16, v16, 4, v7
  s_bfe_u32 s51, s75, 0x10004
  s_lshl_b32 s51, s51, 11
  s_lshr_b32 s50, s75, 5
  s_lshl_b32 s50, s50, 10
  s_add_u32 s51, s51, s50
  s_and_b32 s50, s75, 7
  s_lshl_b32 s50, s50, 7
  s_add_u32 s51, s51, s50
  s_and_b32 s50, s75, 8
  s_add_u32 s51, s51, s50
  s_cmp_eq_u64 s[68:69], 0
  s_cbranch_scc1 L_poll_ok
  s_mov_b64 exec, s[68:69]
  buffer_load_dwordx4 v[216:219], v69, s[44:47], s53 offen sc1
  buffer_load_dwordx4 v[204:207], v69, s[44:47], s76 offen sc1
  s_mov_b64 exec, -1
L_poll:
  s_waitcnt vmcnt(2)
  v_or3_b32 v7, v232, v233, v234
  v_or3_b32 v7, v7, v235, v220
  v_or3_b32 v7, v7, v221, v222
  v_bitop3_b32 v8, v232, v233, v234 bitop3:0x80
  v_bitop3_b32 v8, v8, v235, v220 bitop3:0x80
  v_bitop3_b32 v8, v8, v221, v222 bitop3:0x80
  v_or_b32 v7, v7, v223
  v_and_b32 v8, v8, v223
  v_and_b32 v7, s74, v7
  v_and_b32 v8, s74, v8
  v_cmp_eq_u32 vcc, v7, v21
  v_cmp_eq_u32 s[70:71], v8, v21
  s_nop 0
  s_and_b64 vcc, vcc, s[70:71]
  s_and_b64 exec, vcc, s[68:69]
  v_and_b32 v44, s54, v232
  v_and_b32 v45, s54, v233
  v_and_b32 v46, s54, v234
  v_and_b32 v47, s54, v235
  v_and_b32 v48, s54, v220
  v_and_b32 v49, s54, v221
  v_and_b32 v50, s54, v222
  v_and_b32 v51, s54, v223
  s_andn2_b64 s[68:69], s[68:69], vcc
  s_cbranch_scc0 L_poll_ok
  s_mov_b64 exec, s[68:69]
  buffer_load_dwordx4 v[232:235], v69, s[44:47], s53 offen sc1
  buffer_load_dwordx4 v[220:223], v69, s[44:47], s76 offen sc1
  s_mov_b64 exec, -1
  s_waitcnt vmcnt(2)
  v_or3_b32 v7, v216, v217, v218
  v_or3_b32 v7, v7, v219, v204
  v_or3_b32 v7, v7, v205, v206
  v_bitop3_b32 v8, v216, v217, v218 bitop3:0x80
  v_bitop3_b32 v8, v8, v219, v204 bitop3:0x80
  v_bitop3_b32 v8, v8, v205, v206 bitop3:0x80
  v_or_b32 v7, v7, v207
  v_and_b32 v8, v8, v207
  v_and_b32 v7, s74, v7
  v_and_b32 v8, s74, v8
  v_cmp_eq_u32 vcc, v7, v21
  v_cmp_eq_u32 s[70:71], v8, v21
  s_nop 0
  s_and_b64 vcc, vcc, s[70:71]
  s_and_b64 exec, vcc, s[68:69]
  v_and_b32 v44, s54, v216
  v_and_b32 v45, s54, v217
  v_and_b32 v46, s54, v218
  v_and_b32 v47, s54, v219
  v_and_b32 v48, s54, v204
  v_and_b32 v49, s54, v205
  v_and_b32 v50, s54, v206
  v_and_b32 v51, s54, v207
  s_andn2_b64 s[68:69], s[68:69], vcc
  s_cbranch_scc0 L_poll_ok
  s_mov_b64 exec, s[68:69]
  buffer_load_dwordx4 v[216:219], v69, s[44:47], s53 offen sc1
  buffer_load_dwordx4 v[204:207], v69, s[44:47], s76 offen sc1
  s_mov_b64 exec, -1
  s_add_u32 s60, s60, 1
  s_cmp_lt_u32 s60, 0x20000
  s_cbranch_scc1 L_poll
L_poll_ok:
  s_mov_b64 exec, -1
  v_mul_f32 v44, v18, v44
  v_mul_f32 v45, v18, v45
  v_mul_f32 v46, v18, v46
  v_mul_f32 v47, v18, v47
  v_fmac_f32 v44, v19, v48
  v_fmac_f32 v45, v19, v49
  v_fmac_f32 v46, v19, v50
  v_fmac_f32 v47, v19, v51
  v_add_f32_dpp v44, v44, v44 row_ror:8 row_mask:0xf bank_mask:0x3
  v_add_f32_dpp v45, v45, v45 row_ror:8 row_mask:0xf bank_mask:0x3
  v_add_f32_dpp v44, v46, v46 row_ror:8 row_mask:0xf bank_mask:0xc
  v_add_f32_dpp v45, v47, v47 row_ror:8 row_mask:0xf bank_mask:0xc
  s_nop 1
  v_permlane16_swap_b32 v44, v45
  v_add_f32 v44, v44, v45
  v_mov_b32 v45, v44
  s_nop 1
  v_permlane32_swap_b32 v44, v45
  v_add_f32 v44, v44, v45
  ds_write_b32 v11, v44 offset:33792
  s_waitcnt lgkmcnt(0)
  s_barrier
  s_cmp_lg_u32 s3, 0
  s_cbranch_scc1 L_fin
  ds_read_b64 v[60:61], v17 offset:33792
  ds_read_b64 v[62:63], v17 offset:33920
  ds_read_b64 v[64:65], v17 offset:34048
  ds_read_b64 v[66:67], v17 offset:34176
  ds_read_b64 v[68:69], v17 offset:34304
  ds_read_b64 v[70:71], v17 offset:34432
  ds_read_b64 v[72:73], v17 offset:34560
  ds_read_b64 v[74:75], v17 offset:34688
  s_waitcnt lgkmcnt(0)
  v_add_f32 v60, v60, v68
  v_add_f32 v61, v61, v69
  v_add_f32 v62, v62, v70
  v_add_f32 v63, v63, v71
  v_add_f32 v64, v64, v72
  v_add_f32 v65, v65, v73
  v_add_f32 v66, v66, v74
  v_add_f32 v67, v67, v75
  v_add_f32 v60, v60, v64
  v_add_f32 v61, v61, v65
  v_add_f32 v62, v62, v66
  v_add_f32 v63, v63, v67
  v_add_f32 v60, v60, v62
  v_add_f32 v61, v61, v63
  v_cvt_pk_bf16_f32 v7, v60, v61
  s_mov_b64 exec, 0xffff
  buffer_store_dword v7, v16, s[40:43], s51 offen sc1
  s_cmp_lg_u32 s75, 32
  s_cbranch_scc1 L_fin
  s_mov_b64 exec, 1
  s_mov_b32 s7, 0x1b0000
  buffer_store_dword v15, v16, s[44:47], s7 offen sc1
L_fin:
L_end:
  s_endpgm
.section .rodata,"a"
.p2align 6
.amdhsa_kernel concat_heads__sliding_block_cached__mha_block_cached__decode_kernel
  .amdhsa_next_free_vgpr 256
  .amdhsa_next_free_sgpr 80
  .amdhsa_accum_offset 256
  .amdhsa_group_segment_fixed_size 0
  .amdhsa_kernarg_size 104
  .amdhsa_user_sgpr_count 2
  .amdhsa_user_sgpr_kernarg_segment_ptr 1
  .amdhsa_system_sgpr_workgroup_id_x 1
.end_amdhsa_kernel
```
